```python
import torch

def _softmax(x, axis=-1):
    return torch.softmax(x, dim=axis)
def _gelu(x):
    return torch.nn.functional.gelu(x, approximate="tanh")
def _silu(x):
    return torch.nn.functional.silu(x)
def _sigmoid(x):
    return torch.sigmoid(x)
def _layernorm(x, axis=-1, eps=1e-5):
    m = x.mean(dim=axis, keepdim=True)
    v = x.var(dim=axis, keepdim=True, unbiased=False)
    return (x - m) / torch.sqrt(v + eps)
def _scatter_add(tgt, idx, src, axis=0):
    return tgt.clone().index_add_(axis, idx, src)
def _segment_sum(src, seg, n):
    out = torch.zeros((n,) + src.shape[1:], dtype=src.dtype)
    return out.index_add_(0, seg, src)
def _pad(x, pw):
    flat = tuple(v for pair in reversed(pw) for v in pair)
    return torch.nn.functional.pad(x, flat)

kernel_name = 'gated_mix__softmax_full_mha__linear_kernel_hedgehog__prompt'

def setup_inputs():

    _w = (lambda a: (lambda t: t.to(torch.bfloat16) if t.is_floating_point() else t)(torch.as_tensor(a)))
    def _A_setup():
        B, S, D = 1, 2048, 640
        return {
            "x": _w((lambda *s: torch.randn(*s, dtype=torch.bfloat16) * 0.05)(B, S, D)),
            "wqkv": _w((lambda *s: torch.randn(*s, dtype=torch.bfloat16) * 0.8)(D, 3 * D)),
            "wo": _w((lambda *s: torch.randn(*s, dtype=torch.bfloat16) * 0.05)(D, D)),
        }
    _A_in = _A_setup()

    def _B_setup():
        B, S, D, H = 1, 2048, 640, 32
        Dh = D // H
        return {
            "x": _w((lambda *s: torch.randn(*s, dtype=torch.bfloat16) * 0.05)(B, S, D)),
            "wqkv": _w((lambda *s: torch.randn(*s, dtype=torch.bfloat16) * 1.6)(D, 3 * D)),
            "w_phi": _w((lambda *s: torch.randn(*s, dtype=torch.bfloat16) * 1.6)(H, Dh, Dh) * (Dh ** -0.5)),
            "wo": _w((lambda *s: torch.randn(*s, dtype=torch.bfloat16) * 0.05)(D, D)),
        }
    _B_in = _B_setup()

    return {
        "A_x": _A_in["x"],
        "A_wqkv": _A_in["wqkv"],
        "A_wo": _A_in["wo"],
        "B_x": _B_in["x"],
        "B_wqkv": _B_in["wqkv"],
        "B_w_phi": _B_in["w_phi"],
        "B_wo": _B_in["wo"],
        "gate_w": _w((lambda *s: torch.randn(*s, dtype=torch.bfloat16) * 0.05)(640) * 16.0),
    }

def reference(A_x, A_wqkv, A_wo, B_x, B_wqkv, B_w_phi, B_wo, gate_w):
    def _A_ref(x, wqkv, wo):
        B, S, D = x.shape
        H = 32; Dh = D // H
        qkv = (lambda x, *d: x.permute(*d))((x @ wqkv).reshape(B, S, 3, H, Dh), 2, 0, 3, 1, 4)
        q, k, v = qkv[0], qkv[1], qkv[2]
        scale = Dh ** -0.5
        scores = torch.einsum("bhqd,bhkd->bhqk", q, k) * scale
        p = _softmax(scores, axis=-1)
        o = torch.einsum("bhqk,bhkd->bhqd", p, v)
        return (lambda x, *d: x.permute(*d))(o, 0, 2, 1, 3).reshape(B, S, D) @ wo

    def _B_ref(x, wqkv, w_phi, wo):
        B, S, D = x.shape
        H = 32; Dh = D // H
        qkv = (lambda x, *d: x.permute(*d))((x @ wqkv).reshape(B, S, 3, H, Dh), 2, 0, 3, 1, 4)
        q, k, v = qkv[0], qkv[1], qkv[2]
        pq = torch.einsum("bhsd,hdf->bhsf", q, w_phi)
        pk = torch.einsum("bhsd,hdf->bhsf", k, w_phi)
        phi_q = torch.concatenate([_softmax(pq, axis=-1), _softmax(-pq, axis=-1)], axis=-1)
        phi_k = torch.concatenate([_softmax(pk, axis=-1), _softmax(-pk, axis=-1)], axis=-1)
        kv = torch.einsum("bhsf,bhsd->bhfd", phi_k, v)
        z  = torch.einsum("bhsf->bhf", phi_k)
        num = torch.einsum("bhqf,bhfd->bhqd", phi_q, kv)
        den = torch.einsum("bhqf,bhf->bhq", phi_q, z)[..., None] + 1e-6
        o = num / den
        return (lambda x, *d: x.permute(*d))(o, 0, 2, 1, 3).reshape(B, S, D) @ wo

    x = A_x
    g = _sigmoid((x * gate_w).sum(-1, keepdims=True))
    a = _A_ref(x, A_wqkv, A_wo)
    b = _B_ref(x, B_wqkv, B_w_phi, B_wo)
    return g * a + (1 - g) * b
```

```asm
; @launch kernel=k1_kernel grid=(256,1,1) block=(512,1,1) lds=155776
; @launch kernel=k2_kernel grid=(256,1,1) block=(1024,1,1) lds=112256
; @launch kernel=k3_kernel grid=(256,1,1) block=(256,1,1) lds=81920
.amdgcn_target "amdgcn-amd-amdhsa--gfx950"
.text
.globl k1_kernel
.p2align 8
.type k1_kernel,@function
k1_kernel:
    s_cmp_ge_u32 s2, 256
    s_cbranch_scc1 K1_END
    s_load_dwordx4 s[28:31], s[0:1], 0
    s_load_dwordx2 s[34:35], s[0:1], 32
    s_load_dwordx2 s[36:37], s[0:1], 40
    s_load_dwordx2 s[38:39], s[0:1], 56
    s_load_dwordx2 s[40:41], s[0:1], 80
    s_load_dwordx2 s[48:49], s[0:1], 16
    s_load_dwordx2 s[50:51], s[0:1], 48
    s_lshr_b32 s27, s2, 3
    s_bfe_u32 s21, s2, 0x10001
    s_lshl_b32 s21, s21, 3
    s_and_b32 s42, s27, 7
    s_add_u32 s21, s21, s42
    s_and_b32 s20, s2, 1
    s_bfe_u32 s43, s2, 0x10002
    s_lshl_b32 s43, s43, 2
    s_lshr_b32 s22, s27, 3
    s_add_u32 s22, s22, s43
    v_lshrrev_b32 v11, 6, v0
    v_and_b32 v0, 63, v0
    v_readfirstlane_b32 s23, v11
    v_and_b32 v1, 15, v0
    v_lshrrev_b32 v2, 4, v0
    s_and_b32 s24, s23, 3
    s_lshr_b32 s25, s23, 2
    s_add_u32 s42, s23, 0
    s_lshl_b32 s84, s42, 10
    s_add_u32 s84, s84, 30720
    s_lshl_b32 s42, s42, 3
    v_lshrrev_b32 v11, 3, v0
    v_add_u32 v11, s42, v11
    v_and_b32 v12, 7, v0
    v_and_b32 v13, 7, v11
    v_xor_b32 v12, v12, v13
    s_lshl_b32 s43, s21, 7
    v_add_u32 v11, s43, v11
    v_mul_u32_u24 v11, 1280, v11
    v_lshl_add_u32 v7, v12, 4, v11
    s_add_u32 s42, s23, 8
    s_lshl_b32 s85, s42, 10
    s_add_u32 s85, s85, 30720
    s_lshl_b32 s42, s42, 3
    v_lshrrev_b32 v11, 3, v0
    v_add_u32 v11, s42, v11
    v_and_b32 v12, 7, v0
    v_and_b32 v13, 7, v11
    v_xor_b32 v12, v12, v13
    s_lshl_b32 s43, s21, 7
    v_add_u32 v11, s43, v11
    v_mul_u32_u24 v11, 1280, v11
    v_lshl_add_u32 v8, v12, 4, v11
    s_mul_i32 s47, s22, 160
    s_add_u32 s42, s23, 0
    s_min_u32 s42, s42, 29
    s_mul_i32 s43, s42, 205
    s_lshr_b32 s43, s43, 11
    s_mov_b32 s76, s43
    s_mul_i32 s44, s43, 10
    s_sub_u32 s44, s42, s44
    s_lshl_b32 s80, s42, 10
    s_xor_b32 s45, s43, s20
    s_cmp_eq_u32 s43, 2
    s_cselect_b32 s45, 2, s45
    s_mul_i32 s45, s45, 1280
    s_add_u32 s45, s45, s47
    s_lshl_b32 s44, s44, 6
    v_add_u32 v11, s44, v0
    v_mul_u32_u24 v12, 6554, v11
    v_lshrrev_b32 v12, 16, v12
    v_mul_u32_u24 v13, 10, v12
    v_sub_u32 v13, v11, v13
    v_lshrrev_b32 v11, 1, v12
    v_and_b32 v11, 4, v11
    v_xor_b32 v12, v12, v11
    v_mul_u32_u24 v12, 3840, v12
    v_lshl_add_u32 v12, v13, 4, v12
    v_add_u32 v3, s45, v12
    s_add_u32 s42, s23, 8
    s_min_u32 s42, s42, 29
    s_mul_i32 s43, s42, 205
    s_lshr_b32 s43, s43, 11
    s_mov_b32 s77, s43
    s_mul_i32 s44, s43, 10
    s_sub_u32 s44, s42, s44
    s_lshl_b32 s81, s42, 10
    s_xor_b32 s45, s43, s20
    s_cmp_eq_u32 s43, 2
    s_cselect_b32 s45, 2, s45
    s_mul_i32 s45, s45, 1280
    s_add_u32 s45, s45, s47
    s_lshl_b32 s44, s44, 6
    v_add_u32 v11, s44, v0
    v_mul_u32_u24 v12, 6554, v11
    v_lshrrev_b32 v12, 16, v12
    v_mul_u32_u24 v13, 10, v12
    v_sub_u32 v13, v11, v13
    v_lshrrev_b32 v11, 1, v12
    v_and_b32 v11, 4, v11
    v_xor_b32 v12, v12, v11
    v_mul_u32_u24 v12, 3840, v12
    v_lshl_add_u32 v12, v13, 4, v12
    v_add_u32 v4, s45, v12
    s_add_u32 s42, s23, 16
    s_min_u32 s42, s42, 29
    s_mul_i32 s43, s42, 205
    s_lshr_b32 s43, s43, 11
    s_mov_b32 s78, s43
    s_mul_i32 s44, s43, 10
    s_sub_u32 s44, s42, s44
    s_lshl_b32 s82, s42, 10
    s_xor_b32 s45, s43, s20
    s_cmp_eq_u32 s43, 2
    s_cselect_b32 s45, 2, s45
    s_mul_i32 s45, s45, 1280
    s_add_u32 s45, s45, s47
    s_lshl_b32 s44, s44, 6
    v_add_u32 v11, s44, v0
    v_mul_u32_u24 v12, 6554, v11
    v_lshrrev_b32 v12, 16, v12
    v_mul_u32_u24 v13, 10, v12
    v_sub_u32 v13, v11, v13
    v_lshrrev_b32 v11, 1, v12
    v_and_b32 v11, 4, v11
    v_xor_b32 v12, v12, v11
    v_mul_u32_u24 v12, 3840, v12
    v_lshl_add_u32 v12, v13, 4, v12
    v_add_u32 v5, s45, v12
    s_add_u32 s42, s23, 24
    s_min_u32 s42, s42, 29
    s_mul_i32 s43, s42, 205
    s_lshr_b32 s43, s43, 11
    s_mov_b32 s79, s43
    s_mul_i32 s44, s43, 10
    s_sub_u32 s44, s42, s44
    s_lshl_b32 s83, s42, 10
    s_xor_b32 s45, s43, s20
    s_cmp_eq_u32 s43, 2
    s_cselect_b32 s45, 2, s45
    s_mul_i32 s45, s45, 1280
    s_add_u32 s45, s45, s47
    s_lshl_b32 s44, s44, 6
    v_add_u32 v11, s44, v0
    v_mul_u32_u24 v12, 6554, v11
    v_lshrrev_b32 v12, 16, v12
    v_mul_u32_u24 v13, 10, v12
    v_sub_u32 v13, v11, v13
    v_lshrrev_b32 v11, 1, v12
    v_and_b32 v11, 4, v11
    v_xor_b32 v12, v12, v11
    v_mul_u32_u24 v12, 3840, v12
    v_lshl_add_u32 v12, v13, 4, v12
    v_add_u32 v6, s45, v12
    s_waitcnt lgkmcnt(0)
    s_mov_b32 s4, s28
    s_and_b32 s5, s29, 0xffff
    s_mov_b32 s6, 2621440
    s_mov_b32 s7, 0x00020000
    s_cmp_eq_u32 s76, 1
    s_cselect_b32 s42, 1, 0
    s_lshr_b32 s43, s76, 1
    s_andn2_b32 s43, s43, s20
    s_or_b32 s42, s42, s43
    s_cmp_lg_u32 s42, 0
    s_cselect_b32 s64, s34, s30
    s_cselect_b32 s46, s35, s31
    s_and_b32 s65, s46, 0xffff
    s_mov_b32 s66, 2457600
    s_mov_b32 s67, 0x00020000
    s_cmp_eq_u32 s77, 1
    s_cselect_b32 s42, 1, 0
    s_lshr_b32 s43, s77, 1
    s_andn2_b32 s43, s43, s20
    s_or_b32 s42, s42, s43
    s_cmp_lg_u32 s42, 0
    s_cselect_b32 s68, s34, s30
    s_cselect_b32 s46, s35, s31
    s_and_b32 s69, s46, 0xffff
    s_mov_b32 s70, 2457600
    s_mov_b32 s71, 0x00020000
    s_cmp_eq_u32 s78, 1
    s_cselect_b32 s42, 1, 0
    s_lshr_b32 s43, s78, 1
    s_andn2_b32 s43, s43, s20
    s_or_b32 s42, s42, s43
    s_cmp_lg_u32 s42, 0
    s_cselect_b32 s72, s34, s30
    s_cselect_b32 s46, s35, s31
    s_and_b32 s73, s46, 0xffff
    s_mov_b32 s74, 2457600
    s_mov_b32 s75, 0x00020000
    s_cmp_eq_u32 s79, 1
    s_cselect_b32 s42, 1, 0
    s_lshr_b32 s43, s79, 1
    s_andn2_b32 s43, s43, s20
    s_or_b32 s42, s42, s43
    s_cmp_lg_u32 s42, 0
    s_cselect_b32 s76, s34, s30
    s_cselect_b32 s46, s35, s31
    s_and_b32 s77, s46, 0xffff
    s_mov_b32 s78, 2457600
    s_mov_b32 s79, 0x00020000
    s_getreg_b32 s42, hwreg(HW_REG_XCC_ID)
    s_and_b32 s42, s42, 7
    s_mul_i32 s42, s42, 5
    s_lshr_b32 s42, s42, 2
    s_mul_i32 s86, s42, 245760
    s_lshl_b32 s87, s42, 7
    s_add_u32 m0, s84, 0
    s_nop 0
    buffer_load_dwordx4 v7, s[4:7], s87 offen lds
    s_add_u32 m0, s85, 0
    s_nop 0
    buffer_load_dwordx4 v8, s[4:7], s87 offen lds
    s_add_u32 m0, s80, 0
    s_nop 0
    buffer_load_dwordx4 v3, s[64:67], s86 offen lds
    s_add_u32 m0, s81, 0
    s_nop 0
    buffer_load_dwordx4 v4, s[68:71], s86 offen lds
    s_add_u32 m0, s82, 0
    s_nop 0
    buffer_load_dwordx4 v5, s[72:75], s86 offen lds
    s_add_u32 m0, s83, 0
    s_nop 0
    buffer_load_dwordx4 v6, s[76:79], s86 offen lds
    s_add_u32 s86, s86, 245760
    s_add_u32 s87, s87, 128
    s_cmp_eq_u32 s87, 1280
    s_cselect_b32 s86, 0, s86
    s_cselect_b32 s87, 0, s87
    s_mov_b32 s8, s36
    s_and_b32 s9, s37, 0xffff
    s_mov_b32 s10, 25600
    s_mov_b32 s11, 0x00020000
    s_mul_i32 s42, s22, 3200
    s_lshl_b32 s43, s23, 6
    v_add_u32 v11, s43, v0
    v_lshlrev_b32 v12, 4, v11
    v_add_u32 v13, s42, v12
    v_mov_b32 v244, 0
    v_mov_b32 v245, 0
    v_mov_b32 v246, 0
    v_mov_b32 v247, 0
    v_cmp_gt_u32 vcc, 200, v11
    s_nop 1
    s_and_saveexec_b64 s[52:53], vcc
    buffer_load_dwordx4 v[244:247], v13, s[8:11], 0 offen
    s_mov_b64 exec, s[52:53]
    s_add_u32 m0, s84, 47104
    s_nop 0
    buffer_load_dwordx4 v7, s[4:7], s87 offen lds
    s_add_u32 m0, s85, 47104
    s_nop 0
    buffer_load_dwordx4 v8, s[4:7], s87 offen lds
    s_add_u32 m0, s80, 47104
    s_nop 0
    buffer_load_dwordx4 v3, s[64:67], s86 offen lds
    s_add_u32 m0, s81, 47104
    s_nop 0
    buffer_load_dwordx4 v4, s[68:71], s86 offen lds
    s_add_u32 m0, s82, 47104
    s_nop 0
    buffer_load_dwordx4 v5, s[72:75], s86 offen lds
    s_add_u32 m0, s83, 47104
    s_nop 0
    buffer_load_dwordx4 v6, s[76:79], s86 offen lds
    s_add_u32 s86, s86, 245760
    s_add_u32 s87, s87, 128
    s_cmp_eq_u32 s87, 1280
    s_cselect_b32 s86, 0, s86
    s_cselect_b32 s87, 0, s87
    s_mov_b32 s60, 0
    s_cmp_ge_u32 s23, 2
    s_cbranch_scc1 K1_NOREP
    s_lshl_b32 s42, s23, 8
    s_add_u32 s42, s42, s2
    s_cmp_ge_u32 s42, 320
    s_cbranch_scc1 K1_NOREP
    s_mov_b32 s60, 1
    s_and_b32 s43, s42, 7
    s_lshr_b32 s44, s42, 3
    s_cmp_lt_u32 s44, 20
    s_cselect_b32 s12, s48, s50
    s_cselect_b32 s47, s49, s51
    s_cselect_b32 s45, 0, 20
    s_and_b32 s13, s47, 0xffff
    s_mov_b32 s14, 819200
    s_mov_b32 s15, 0x00020000
    s_sub_u32 s45, s44, s45
    s_mul_i32 s45, s45, 40960
    s_mul_i32 s47, s43, 160
    s_add_u32 s45, s45, s47
    s_mul_i32 s61, s23, 5120
    s_add_u32 s61, s61, 145536
    v_add_u32 v11, 0, v0
    v_mul_u32_u24 v12, 205, v11
    v_lshrrev_b32 v12, 11, v12
    v_mul_u32_u24 v13, 10, v12
    v_sub_u32 v13, v11, v13
    v_mul_u32_u24 v12, 1280, v12
    v_lshl_add_u32 v12, v13, 4, v12
    s_add_u32 m0, s61, 0
    s_nop 0
    buffer_load_dwordx4 v12, s[12:15], s45 offen lds
    v_add_u32 v11, 64, v0
    v_mul_u32_u24 v12, 205, v11
    v_lshrrev_b32 v12, 11, v12
    v_mul_u32_u24 v13, 10, v12
    v_sub_u32 v13, v11, v13
    v_mul_u32_u24 v12, 1280, v12
    v_lshl_add_u32 v12, v13, 4, v12
    s_add_u32 m0, s61, 1024
    s_nop 0
    buffer_load_dwordx4 v12, s[12:15], s45 offen lds
    v_add_u32 v11, 128, v0
    v_mul_u32_u24 v12, 205, v11
    v_lshrrev_b32 v12, 11, v12
    v_mul_u32_u24 v13, 10, v12
    v_sub_u32 v13, v11, v13
    v_mul_u32_u24 v12, 1280, v12
    v_lshl_add_u32 v12, v13, 4, v12
    s_add_u32 m0, s61, 2048
    s_nop 0
    buffer_load_dwordx4 v12, s[12:15], s45 offen lds
    v_add_u32 v11, 192, v0
    v_mul_u32_u24 v12, 205, v11
    v_lshrrev_b32 v12, 11, v12
    v_mul_u32_u24 v13, 10, v12
    v_sub_u32 v13, v11, v13
    v_mul_u32_u24 v12, 1280, v12
    v_lshl_add_u32 v12, v13, 4, v12
    s_add_u32 m0, s61, 3072
    s_nop 0
    buffer_load_dwordx4 v12, s[12:15], s45 offen lds
    v_add_u32 v11, 256, v0
    v_mul_u32_u24 v12, 205, v11
    v_lshrrev_b32 v12, 11, v12
    v_mul_u32_u24 v13, 10, v12
    v_sub_u32 v13, v11, v13
    v_mul_u32_u24 v12, 1280, v12
    v_lshl_add_u32 v12, v13, 4, v12
    s_add_u32 m0, s61, 4096
    s_nop 0
    buffer_load_dwordx4 v12, s[12:15], s45 offen lds
    s_mul_i32 s47, s43, 40
    s_add_u32 s47, s47, s44
    s_mul_i32 s62, s47, 5120
    s_add_u32 s62, s62, 21929984
K1_NOREP:
    s_mov_b32 s56, s40
    s_and_b32 s57, s41, 0xffff
    s_mov_b32 s58, 23568384
    s_mov_b32 s59, 0x00020000
    v_lshrrev_b32 v11, 2, v1
    v_and_b32 v12, 3, v1
    v_and_b32 v13, 1, v2
    v_lshl_add_u32 v14, v2, 3, v11
    v_lshl_add_u32 v14, v13, 2, v14
    v_xor_b32 v13, 4, v14
    v_mul_u32_u24 v12, 40, v12
    v_mul_u32_u24 v14, 160, v14
    v_mul_u32_u24 v13, 160, v13
    v_add_u32 v9, v14, v12
    v_add_u32 v10, v13, v12
    v_and_b32 v12, 7, v1
    v_xor_b32 v11, v2, v12
    s_lshl_b32 s42, s24, 5
    v_add_u32 v12, s42, v1
    v_lshlrev_b32 v12, 7, v12
    v_lshl_add_u32 v12, v11, 4, v12
    v_add_u32 v15, 30720, v12
    v_xor_b32 v166, 64, v15
    v_add_u32 v160, 47104, v9
    v_add_u32 v161, 47104, v10
    v_add_u32 v164, 47104, v15
    v_add_u32 v167, 47104, v166
    v_add_u32 v162, 94208, v9
    v_add_u32 v163, 94208, v10
    v_add_u32 v165, 94208, v15
    v_add_u32 v168, 94208, v166
    s_lshl_b32 s46, s21, 7
    s_lshl_b32 s42, s24, 5
    s_add_u32 s46, s46, s42
    v_mov_b32 v16, 0
    v_mov_b32 v17, 0
    v_mov_b32 v18, 0
    v_mov_b32 v19, 0
    v_mov_b32 v20, 0
    v_mov_b32 v21, 0
    v_mov_b32 v22, 0
    v_mov_b32 v23, 0
    v_mov_b32 v24, 0
    v_mov_b32 v25, 0
    v_mov_b32 v26, 0
    v_mov_b32 v27, 0
    v_mov_b32 v28, 0
    v_mov_b32 v29, 0
    v_mov_b32 v30, 0
    v_mov_b32 v31, 0
    v_mov_b32 v32, 0
    v_mov_b32 v33, 0
    v_mov_b32 v34, 0
    v_mov_b32 v35, 0
    v_mov_b32 v36, 0
    v_mov_b32 v37, 0
    v_mov_b32 v38, 0
    v_mov_b32 v39, 0
    v_mov_b32 v40, 0
    v_mov_b32 v41, 0
    v_mov_b32 v42, 0
    v_mov_b32 v43, 0
    v_mov_b32 v44, 0
    v_mov_b32 v45, 0
    v_mov_b32 v46, 0
    v_mov_b32 v47, 0
    v_mov_b32 v48, 0
    v_mov_b32 v49, 0
    v_mov_b32 v50, 0
    v_mov_b32 v51, 0
    v_mov_b32 v52, 0
    v_mov_b32 v53, 0
    v_mov_b32 v54, 0
    v_mov_b32 v55, 0
    v_mov_b32 v56, 0
    v_mov_b32 v57, 0
    v_mov_b32 v58, 0
    v_mov_b32 v59, 0
    v_mov_b32 v60, 0
    v_mov_b32 v61, 0
    v_mov_b32 v62, 0
    v_mov_b32 v63, 0
    v_mov_b32 v64, 0
    v_mov_b32 v65, 0
    v_mov_b32 v66, 0
    v_mov_b32 v67, 0
    v_mov_b32 v68, 0
    v_mov_b32 v69, 0
    v_mov_b32 v70, 0
    v_mov_b32 v71, 0
    v_mov_b32 v72, 0
    v_mov_b32 v73, 0
    v_mov_b32 v74, 0
    v_mov_b32 v75, 0
    v_mov_b32 v76, 0
    v_mov_b32 v77, 0
    v_mov_b32 v78, 0
    v_mov_b32 v79, 0
    s_cmp_eq_u32 s60, 0
    s_cbranch_scc1 K1_W0
    s_waitcnt vmcnt(12)
    s_branch K1_W1
K1_W0:
    s_waitcnt vmcnt(7)
K1_W1:
    s_barrier
    s_cmp_eq_u32 s25, 0
    s_cbranch_scc0 K1_M1
    ds_read_b128 v[112:115], v15
    ds_read_b128 v[116:119], v15 offset:2048
    ds_read_b128 v[120:123], v166
    ds_read_b128 v[124:127], v166 offset:2048
    ds_read_b64_tr_b16 v[80:81], v9 offset:0
    ds_read_b64_tr_b16 v[82:83], v10 offset:0
    ds_read_b64_tr_b16 v[84:85], v9 offset:8
    ds_read_b64_tr_b16 v[86:87], v10 offset:8
    ds_read_b64_tr_b16 v[88:89], v9 offset:16
    ds_read_b64_tr_b16 v[90:91], v10 offset:16
    ds_read_b64_tr_b16 v[92:93], v9 offset:24
    ds_read_b64_tr_b16 v[94:95], v10 offset:24
    ds_read_b64_tr_b16 v[96:97], v9 offset:32
    ds_read_b64_tr_b16 v[98:99], v10 offset:32
    s_mov_b32 s26, 3
K1_LOOP0:
    s_barrier
    s_waitcnt lgkmcnt(8)
    v_mfma_f32_16x16x32_bf16 v[16:19], v[80:83], v[112:115], v[16:19]
    v_mfma_f32_16x16x32_bf16 v[20:23], v[80:83], v[116:119], v[20:23]
    ds_read_b64_tr_b16 v[100:101], v9 offset:10240
    ds_read_b64_tr_b16 v[102:103], v10 offset:10240
    s_add_u32 m0, s84, 94208
    s_nop 0
    buffer_load_dwordx4 v7, s[4:7], s87 offen lds
    s_waitcnt lgkmcnt(8)
    v_mfma_f32_16x16x32_bf16 v[24:27], v[84:87], v[112:115], v[24:27]
    v_mfma_f32_16x16x32_bf16 v[28:31], v[84:87], v[116:119], v[28:31]
    ds_read_b64_tr_b16 v[104:105], v9 offset:10248
    ds_read_b64_tr_b16 v[106:107], v10 offset:10248
    s_add_u32 m0, s85, 94208
    s_nop 0
    buffer_load_dwordx4 v8, s[4:7], s87 offen lds
    s_waitcnt lgkmcnt(8)
    v_mfma_f32_16x16x32_bf16 v[32:35], v[88:91], v[112:115], v[32:35]
    v_mfma_f32_16x16x32_bf16 v[36:39], v[88:91], v[116:119], v[36:39]
    ds_read_b64_tr_b16 v[108:109], v9 offset:10256
    ds_read_b64_tr_b16 v[110:111], v10 offset:10256
    s_add_u32 m0, s80, 94208
    s_nop 0
    buffer_load_dwordx4 v3, s[64:67], s86 offen lds
    s_waitcnt lgkmcnt(8)
    v_mfma_f32_16x16x32_bf16 v[40:43], v[92:95], v[112:115], v[40:43]
    v_mfma_f32_16x16x32_bf16 v[44:47], v[92:95], v[116:119], v[44:47]
    ds_read_b64_tr_b16 v[80:81], v9 offset:5120
    ds_read_b64_tr_b16 v[82:83], v10 offset:5120
    s_add_u32 m0, s81, 94208
    s_nop 0
    buffer_load_dwordx4 v4, s[68:71], s86 offen lds
    s_waitcnt lgkmcnt(8)
    v_mfma_f32_16x16x32_bf16 v[48:51], v[96:99], v[112:115], v[48:51]
    v_mfma_f32_16x16x32_bf16 v[52:55], v[96:99], v[116:119], v[52:55]
    ds_read_b64_tr_b16 v[84:85], v9 offset:5128
    ds_read_b64_tr_b16 v[86:87], v10 offset:5128
    s_add_u32 m0, s82, 94208
    s_nop 0
    buffer_load_dwordx4 v5, s[72:75], s86 offen lds
    s_waitcnt lgkmcnt(8)
    v_mfma_f32_16x16x32_bf16 v[56:59], v[100:103], v[112:115], v[56:59]
    v_mfma_f32_16x16x32_bf16 v[60:63], v[100:103], v[116:119], v[60:63]
    ds_read_b64_tr_b16 v[88:89], v9 offset:5136
    ds_read_b64_tr_b16 v[90:91], v10 offset:5136
    s_add_u32 m0, s83, 94208
    s_nop 0
    buffer_load_dwordx4 v6, s[76:79], s86 offen lds
    s_waitcnt lgkmcnt(8)
    v_mfma_f32_16x16x32_bf16 v[64:67], v[104:107], v[112:115], v[64:67]
    v_mfma_f32_16x16x32_bf16 v[68:71], v[104:107], v[116:119], v[68:71]
    ds_read_b64_tr_b16 v[92:93], v9 offset:5144
    ds_read_b64_tr_b16 v[94:95], v10 offset:5144
    s_add_u32 s86, s86, 245760
    s_add_u32 s87, s87, 128
    s_cmp_eq_u32 s87, 1280
    s_cselect_b32 s86, 0, s86
    s_cselect_b32 s87, 0, s87
    s_waitcnt lgkmcnt(8)
    v_mfma_f32_16x16x32_bf16 v[72:75], v[108:111], v[112:115], v[72:75]
    v_mfma_f32_16x16x32_bf16 v[76:79], v[108:111], v[116:119], v[76:79]
    ds_read_b64_tr_b16 v[96:97], v9 offset:5152
    ds_read_b64_tr_b16 v[98:99], v10 offset:5152
    s_waitcnt lgkmcnt(8)
    v_mfma_f32_16x16x32_bf16 v[16:19], v[80:83], v[120:123], v[16:19]
    v_mfma_f32_16x16x32_bf16 v[20:23], v[80:83], v[124:127], v[20:23]
    ds_read_b64_tr_b16 v[100:101], v9 offset:15360
    ds_read_b64_tr_b16 v[102:103], v10 offset:15360
    s_waitcnt lgkmcnt(8)
    v_mfma_f32_16x16x32_bf16 v[24:27], v[84:87], v[120:123], v[24:27]
    v_mfma_f32_16x16x32_bf16 v[28:31], v[84:87], v[124:127], v[28:31]
    ds_read_b64_tr_b16 v[104:105], v9 offset:15368
    ds_read_b64_tr_b16 v[106:107], v10 offset:15368
    s_waitcnt lgkmcnt(8)
    v_mfma_f32_16x16x32_bf16 v[32:35], v[88:91], v[120:123], v[32:35]
    v_mfma_f32_16x16x32_bf16 v[36:39], v[88:91], v[124:127], v[36:39]
    ds_read_b64_tr_b16 v[108:109], v9 offset:15376
    ds_read_b64_tr_b16 v[110:111], v10 offset:15376
    s_waitcnt lgkmcnt(8)
    v_mfma_f32_16x16x32_bf16 v[40:43], v[92:95], v[120:123], v[40:43]
    v_mfma_f32_16x16x32_bf16 v[44:47], v[92:95], v[124:127], v[44:47]
    s_waitcnt vmcnt(6)
    s_barrier
    ds_read_b128 v[128:131], v164
    ds_read_b128 v[132:135], v164 offset:2048
    ds_read_b128 v[136:139], v167
    ds_read_b128 v[140:143], v167 offset:2048
    ds_read_b64_tr_b16 v[80:81], v160 offset:0
    ds_read_b64_tr_b16 v[82:83], v161 offset:0
    s_waitcnt lgkmcnt(12)
    v_mfma_f32_16x16x32_bf16 v[48:51], v[96:99], v[120:123], v[48:51]
    v_mfma_f32_16x16x32_bf16 v[52:55], v[96:99], v[124:127], v[52:55]
    ds_read_b64_tr_b16 v[84:85], v160 offset:8
    ds_read_b64_tr_b16 v[86:87], v161 offset:8
    s_waitcnt lgkmcnt(12)
    v_mfma_f32_16x16x32_bf16 v[56:59], v[100:103], v[120:123], v[56:59]
    v_mfma_f32_16x16x32_bf16 v[60:63], v[100:103], v[124:127], v[60:63]
    ds_read_b64_tr_b16 v[88:89], v160 offset:16
    ds_read_b64_tr_b16 v[90:91], v161 offset:16
    s_waitcnt lgkmcnt(12)
    v_mfma_f32_16x16x32_bf16 v[64:67], v[104:107], v[120:123], v[64:67]
    v_mfma_f32_16x16x32_bf16 v[68:71], v[104:107], v[124:127], v[68:71]
    ds_read_b64_tr_b16 v[92:93], v160 offset:24
    ds_read_b64_tr_b16 v[94:95], v161 offset:24
    s_waitcnt lgkmcnt(12)
    v_mfma_f32_16x16x32_bf16 v[72:75], v[108:111], v[120:123], v[72:75]
    v_mfma_f32_16x16x32_bf16 v[76:79], v[108:111], v[124:127], v[76:79]
    ds_read_b64_tr_b16 v[96:97], v160 offset:32
    ds_read_b64_tr_b16 v[98:99], v161 offset:32
    s_barrier
    s_waitcnt lgkmcnt(8)
    v_mfma_f32_16x16x32_bf16 v[16:19], v[80:83], v[128:131], v[16:19]
    v_mfma_f32_16x16x32_bf16 v[20:23], v[80:83], v[132:135], v[20:23]
    ds_read_b64_tr_b16 v[100:101], v160 offset:10240
    ds_read_b64_tr_b16 v[102:103], v161 offset:10240
    s_add_u32 m0, s84, 0
    s_nop 0
    buffer_load_dwordx4 v7, s[4:7], s87 offen lds
    s_waitcnt lgkmcnt(8)
    v_mfma_f32_16x16x32_bf16 v[24:27], v[84:87], v[128:131], v[24:27]
    v_mfma_f32_16x16x32_bf16 v[28:31], v[84:87], v[132:135], v[28:31]
    ds_read_b64_tr_b16 v[104:105], v160 offset:10248
    ds_read_b64_tr_b16 v[106:107], v161 offset:10248
    s_add_u32 m0, s85, 0
    s_nop 0
    buffer_load_dwordx4 v8, s[4:7], s87 offen lds
    s_waitcnt lgkmcnt(8)
    v_mfma_f32_16x16x32_bf16 v[32:35], v[88:91], v[128:131], v[32:35]
    v_mfma_f32_16x16x32_bf16 v[36:39], v[88:91], v[132:135], v[36:39]
    ds_read_b64_tr_b16 v[108:109], v160 offset:10256
    ds_read_b64_tr_b16 v[110:111], v161 offset:10256
    s_add_u32 m0, s80, 0
    s_nop 0
    buffer_load_dwordx4 v3, s[64:67], s86 offen lds
    s_waitcnt lgkmcnt(8)
    v_mfma_f32_16x16x32_bf16 v[40:43], v[92:95], v[128:131], v[40:43]
    v_mfma_f32_16x16x32_bf16 v[44:47], v[92:95], v[132:135], v[44:47]
    ds_read_b64_tr_b16 v[80:81], v160 offset:5120
    ds_read_b64_tr_b16 v[82:83], v161 offset:5120
    s_add_u32 m0, s81, 0
    s_nop 0
    buffer_load_dwordx4 v4, s[68:71], s86 offen lds
    s_waitcnt lgkmcnt(8)
    v_mfma_f32_16x16x32_bf16 v[48:51], v[96:99], v[128:131], v[48:51]
    v_mfma_f32_16x16x32_bf16 v[52:55], v[96:99], v[132:135], v[52:55]
    ds_read_b64_tr_b16 v[84:85], v160 offset:5128
    ds_read_b64_tr_b16 v[86:87], v161 offset:5128
    s_add_u32 m0, s82, 0
    s_nop 0
    buffer_load_dwordx4 v5, s[72:75], s86 offen lds
    s_waitcnt lgkmcnt(8)
    v_mfma_f32_16x16x32_bf16 v[56:59], v[100:103], v[128:131], v[56:59]
    v_mfma_f32_16x16x32_bf16 v[60:63], v[100:103], v[132:135], v[60:63]
    ds_read_b64_tr_b16 v[88:89], v160 offset:5136
    ds_read_b64_tr_b16 v[90:91], v161 offset:5136
    s_add_u32 m0, s83, 0
    s_nop 0
    buffer_load_dwordx4 v6, s[76:79], s86 offen lds
    s_waitcnt lgkmcnt(8)
    v_mfma_f32_16x16x32_bf16 v[64:67], v[104:107], v[128:131], v[64:67]
    v_mfma_f32_16x16x32_bf16 v[68:71], v[104:107], v[132:135], v[68:71]
    ds_read_b64_tr_b16 v[92:93], v160 offset:5144
    ds_read_b64_tr_b16 v[94:95], v161 offset:5144
    s_add_u32 s86, s86, 245760
    s_add_u32 s87, s87, 128
    s_cmp_eq_u32 s87, 1280
    s_cselect_b32 s86, 0, s86
    s_cselect_b32 s87, 0, s87
    s_waitcnt lgkmcnt(8)
    v_mfma_f32_16x16x32_bf16 v[72:75], v[108:111], v[128:131], v[72:75]
    v_mfma_f32_16x16x32_bf16 v[76:79], v[108:111], v[132:135], v[76:79]
    ds_read_b64_tr_b16 v[96:97], v160 offset:5152
    ds_read_b64_tr_b16 v[98:99], v161 offset:5152
    s_waitcnt lgkmcnt(8)
    v_mfma_f32_16x16x32_bf16 v[16:19], v[80:83], v[136:139], v[16:19]
    v_mfma_f32_16x16x32_bf16 v[20:23], v[80:83], v[140:143], v[20:23]
    ds_read_b64_tr_b16 v[100:101], v160 offset:15360
    ds_read_b64_tr_b16 v[102:103], v161 offset:15360
    s_waitcnt lgkmcnt(8)
    v_mfma_f32_16x16x32_bf16 v[24:27], v[84:87], v[136:139], v[24:27]
    v_mfma_f32_16x16x32_bf16 v[28:31], v[84:87], v[140:143], v[28:31]
    ds_read_b64_tr_b16 v[104:105], v160 offset:15368
    ds_read_b64_tr_b16 v[106:107], v161 offset:15368
    s_waitcnt lgkmcnt(8)
    v_mfma_f32_16x16x32_bf16 v[32:35], v[88:91], v[136:139], v[32:35]
    v_mfma_f32_16x16x32_bf16 v[36:39], v[88:91], v[140:143], v[36:39]
    ds_read_b64_tr_b16 v[108:109], v160 offset:15376
    ds_read_b64_tr_b16 v[110:111], v161 offset:15376
    s_waitcnt lgkmcnt(8)
    v_mfma_f32_16x16x32_bf16 v[40:43], v[92:95], v[136:139], v[40:43]
    v_mfma_f32_16x16x32_bf16 v[44:47], v[92:95], v[140:143], v[44:47]
    s_waitcnt vmcnt(6)
    s_barrier
    ds_read_b128 v[144:147], v165
    ds_read_b128 v[148:151], v165 offset:2048
    ds_read_b128 v[152:155], v168
    ds_read_b128 v[156:159], v168 offset:2048
    ds_read_b64_tr_b16 v[80:81], v162 offset:0
    ds_read_b64_tr_b16 v[82:83], v163 offset:0
    s_waitcnt lgkmcnt(12)
    v_mfma_f32_16x16x32_bf16 v[48:51], v[96:99], v[136:139], v[48:51]
    v_mfma_f32_16x16x32_bf16 v[52:55], v[96:99], v[140:143], v[52:55]
    ds_read_b64_tr_b16 v[84:85], v162 offset:8
    ds_read_b64_tr_b16 v[86:87], v163 offset:8
    s_waitcnt lgkmcnt(12)
    v_mfma_f32_16x16x32_bf16 v[56:59], v[100:103], v[136:139], v[56:59]
    v_mfma_f32_16x16x32_bf16 v[60:63], v[100:103], v[140:143], v[60:63]
    ds_read_b64_tr_b16 v[88:89], v162 offset:16
    ds_read_b64_tr_b16 v[90:91], v163 offset:16
    s_waitcnt lgkmcnt(12)
    v_mfma_f32_16x16x32_bf16 v[64:67], v[104:107], v[136:139], v[64:67]
    v_mfma_f32_16x16x32_bf16 v[68:71], v[104:107], v[140:143], v[68:71]
    ds_read_b64_tr_b16 v[92:93], v162 offset:24
    ds_read_b64_tr_b16 v[94:95], v163 offset:24
    s_waitcnt lgkmcnt(12)
    v_mfma_f32_16x16x32_bf16 v[72:75], v[108:111], v[136:139], v[72:75]
    v_mfma_f32_16x16x32_bf16 v[76:79], v[108:111], v[140:143], v[76:79]
    ds_read_b64_tr_b16 v[96:97], v162 offset:32
    ds_read_b64_tr_b16 v[98:99], v163 offset:32
    s_barrier
    s_cmp_eq_u32 s26, 1
    s_cselect_b32 s6, 0, s6
    s_cselect_b32 s66, 0, s66
    s_cselect_b32 s70, 0, s70
    s_cselect_b32 s74, 0, s74
    s_cselect_b32 s78, 0, s78
    s_waitcnt lgkmcnt(8)
    v_mfma_f32_16x16x32_bf16 v[16:19], v[80:83], v[144:147], v[16:19]
    v_mfma_f32_16x16x32_bf16 v[20:23], v[80:83], v[148:151], v[20:23]
    ds_read_b64_tr_b16 v[100:101], v162 offset:10240
    ds_read_b64_tr_b16 v[102:103], v163 offset:10240
    s_add_u32 m0, s84, 47104
    s_nop 0
    buffer_load_dwordx4 v7, s[4:7], s87 offen lds
    s_waitcnt lgkmcnt(8)
    v_mfma_f32_16x16x32_bf16 v[24:27], v[84:87], v[144:147], v[24:27]
    v_mfma_f32_16x16x32_bf16 v[28:31], v[84:87], v[148:151], v[28:31]
    ds_read_b64_tr_b16 v[104:105], v162 offset:10248
    ds_read_b64_tr_b16 v[106:107], v163 offset:10248
    s_add_u32 m0, s85, 47104
    s_nop 0
    buffer_load_dwordx4 v8, s[4:7], s87 offen lds
    s_waitcnt lgkmcnt(8)
    v_mfma_f32_16x16x32_bf16 v[32:35], v[88:91], v[144:147], v[32:35]
    v_mfma_f32_16x16x32_bf16 v[36:39], v[88:91], v[148:151], v[36:39]
    ds_read_b64_tr_b16 v[108:109], v162 offset:10256
    ds_read_b64_tr_b16 v[110:111], v163 offset:10256
    s_add_u32 m0, s80, 47104
    s_nop 0
    buffer_load_dwordx4 v3, s[64:67], s86 offen lds
    s_waitcnt lgkmcnt(8)
    v_mfma_f32_16x16x32_bf16 v[40:43], v[92:95], v[144:147], v[40:43]
    v_mfma_f32_16x16x32_bf16 v[44:47], v[92:95], v[148:151], v[44:47]
    ds_read_b64_tr_b16 v[80:81], v162 offset:5120
    ds_read_b64_tr_b16 v[82:83], v163 offset:5120
    s_add_u32 m0, s81, 47104
    s_nop 0
    buffer_load_dwordx4 v4, s[68:71], s86 offen lds
    s_waitcnt lgkmcnt(8)
    v_mfma_f32_16x16x32_bf16 v[48:51], v[96:99], v[144:147], v[48:51]
    v_mfma_f32_16x16x32_bf16 v[52:55], v[96:99], v[148:151], v[52:55]
    ds_read_b64_tr_b16 v[84:85], v162 offset:5128
    ds_read_b64_tr_b16 v[86:87], v163 offset:5128
    s_add_u32 m0, s82, 47104
    s_nop 0
    buffer_load_dwordx4 v5, s[72:75], s86 offen lds
    s_waitcnt lgkmcnt(8)
    v_mfma_f32_16x16x32_bf16 v[56:59], v[100:103], v[144:147], v[56:59]
    v_mfma_f32_16x16x32_bf16 v[60:63], v[100:103], v[148:151], v[60:63]
    ds_read_b64_tr_b16 v[88:89], v162 offset:5136
    ds_read_b64_tr_b16 v[90:91], v163 offset:5136
    s_add_u32 m0, s83, 47104
    s_nop 0
    buffer_load_dwordx4 v6, s[76:79], s86 offen lds
    s_waitcnt lgkmcnt(8)
    v_mfma_f32_16x16x32_bf16 v[64:67], v[104:107], v[144:147], v[64:67]
    v_mfma_f32_16x16x32_bf16 v[68:71], v[104:107], v[148:151], v[68:71]
    ds_read_b64_tr_b16 v[92:93], v162 offset:5144
    ds_read_b64_tr_b16 v[94:95], v163 offset:5144
    s_add_u32 s86, s86, 245760
    s_add_u32 s87, s87, 128
    s_cmp_eq_u32 s87, 1280
    s_cselect_b32 s86, 0, s86
    s_cselect_b32 s87, 0, s87
    s_waitcnt lgkmcnt(8)
    v_mfma_f32_16x16x32_bf16 v[72:75], v[108:111], v[144:147], v[72:75]
    v_mfma_f32_16x16x32_bf16 v[76:79], v[108:111], v[148:151], v[76:79]
    ds_read_b64_tr_b16 v[96:97], v162 offset:5152
    ds_read_b64_tr_b16 v[98:99], v163 offset:5152
    s_waitcnt lgkmcnt(8)
    v_mfma_f32_16x16x32_bf16 v[16:19], v[80:83], v[152:155], v[16:19]
    v_mfma_f32_16x16x32_bf16 v[20:23], v[80:83], v[156:159], v[20:23]
    ds_read_b64_tr_b16 v[100:101], v162 offset:15360
    ds_read_b64_tr_b16 v[102:103], v163 offset:15360
    s_waitcnt lgkmcnt(8)
    v_mfma_f32_16x16x32_bf16 v[24:27], v[84:87], v[152:155], v[24:27]
    v_mfma_f32_16x16x32_bf16 v[28:31], v[84:87], v[156:159], v[28:31]
    ds_read_b64_tr_b16 v[104:105], v162 offset:15368
    ds_read_b64_tr_b16 v[106:107], v163 offset:15368
    s_waitcnt lgkmcnt(8)
    v_mfma_f32_16x16x32_bf16 v[32:35], v[88:91], v[152:155], v[32:35]
    v_mfma_f32_16x16x32_bf16 v[36:39], v[88:91], v[156:159], v[36:39]
    ds_read_b64_tr_b16 v[108:109], v162 offset:15376
    ds_read_b64_tr_b16 v[110:111], v163 offset:15376
    s_waitcnt lgkmcnt(8)
    v_mfma_f32_16x16x32_bf16 v[40:43], v[92:95], v[152:155], v[40:43]
    v_mfma_f32_16x16x32_bf16 v[44:47], v[92:95], v[156:159], v[44:47]
    s_waitcnt vmcnt(6)
    s_barrier
    ds_read_b128 v[112:115], v15
    ds_read_b128 v[116:119], v15 offset:2048
    ds_read_b128 v[120:123], v166
    ds_read_b128 v[124:127], v166 offset:2048
    ds_read_b64_tr_b16 v[80:81], v9 offset:0
    ds_read_b64_tr_b16 v[82:83], v10 offset:0
    s_waitcnt lgkmcnt(12)
    v_mfma_f32_16x16x32_bf16 v[48:51], v[96:99], v[152:155], v[48:51]
    v_mfma_f32_16x16x32_bf16 v[52:55], v[96:99], v[156:159], v[52:55]
    ds_read_b64_tr_b16 v[84:85], v9 offset:8
    ds_read_b64_tr_b16 v[86:87], v10 offset:8
    s_waitcnt lgkmcnt(12)
    v_mfma_f32_16x16x32_bf16 v[56:59], v[100:103], v[152:155], v[56:59]
    v_mfma_f32_16x16x32_bf16 v[60:63], v[100:103], v[156:159], v[60:63]
    ds_read_b64_tr_b16 v[88:89], v9 offset:16
    ds_read_b64_tr_b16 v[90:91], v10 offset:16
    s_waitcnt lgkmcnt(12)
    v_mfma_f32_16x16x32_bf16 v[64:67], v[104:107], v[152:155], v[64:67]
    v_mfma_f32_16x16x32_bf16 v[68:71], v[104:107], v[156:159], v[68:71]
    ds_read_b64_tr_b16 v[92:93], v9 offset:24
    ds_read_b64_tr_b16 v[94:95], v10 offset:24
    s_waitcnt lgkmcnt(12)
    v_mfma_f32_16x16x32_bf16 v[72:75], v[108:111], v[152:155], v[72:75]
    v_mfma_f32_16x16x32_bf16 v[76:79], v[108:111], v[156:159], v[76:79]
    ds_read_b64_tr_b16 v[96:97], v9 offset:32
    ds_read_b64_tr_b16 v[98:99], v10 offset:32
    s_sub_u32 s26, s26, 1
    s_cmp_lg_u32 s26, 0
    s_cbranch_scc1 K1_LOOP0
    s_barrier
    s_waitcnt lgkmcnt(8)
    v_mfma_f32_16x16x32_bf16 v[16:19], v[80:83], v[112:115], v[16:19]
    v_mfma_f32_16x16x32_bf16 v[20:23], v[80:83], v[116:119], v[20:23]
    ds_read_b64_tr_b16 v[100:101], v9 offset:10240
    ds_read_b64_tr_b16 v[102:103], v10 offset:10240
    s_waitcnt lgkmcnt(8)
    v_mfma_f32_16x16x32_bf16 v[24:27], v[84:87], v[112:115], v[24:27]
    v_mfma_f32_16x16x32_bf16 v[28:31], v[84:87], v[116:119], v[28:31]
    ds_read_b64_tr_b16 v[104:105], v9 offset:10248
    ds_read_b64_tr_b16 v[106:107], v10 offset:10248
    s_waitcnt lgkmcnt(8)
    v_mfma_f32_16x16x32_bf16 v[32:35], v[88:91], v[112:115], v[32:35]
    v_mfma_f32_16x16x32_bf16 v[36:39], v[88:91], v[116:119], v[36:39]
    ds_read_b64_tr_b16 v[108:109], v9 offset:10256
    ds_read_b64_tr_b16 v[110:111], v10 offset:10256
    s_waitcnt lgkmcnt(8)
    v_mfma_f32_16x16x32_bf16 v[40:43], v[92:95], v[112:115], v[40:43]
    v_mfma_f32_16x16x32_bf16 v[44:47], v[92:95], v[116:119], v[44:47]
    ds_read_b64_tr_b16 v[80:81], v9 offset:5120
    ds_read_b64_tr_b16 v[82:83], v10 offset:5120
    s_waitcnt lgkmcnt(8)
    v_mfma_f32_16x16x32_bf16 v[48:51], v[96:99], v[112:115], v[48:51]
    v_mfma_f32_16x16x32_bf16 v[52:55], v[96:99], v[116:119], v[52:55]
    ds_read_b64_tr_b16 v[84:85], v9 offset:5128
    ds_read_b64_tr_b16 v[86:87], v10 offset:5128
    s_waitcnt lgkmcnt(8)
    v_mfma_f32_16x16x32_bf16 v[56:59], v[100:103], v[112:115], v[56:59]
    v_mfma_f32_16x16x32_bf16 v[60:63], v[100:103], v[116:119], v[60:63]
    ds_read_b64_tr_b16 v[88:89], v9 offset:5136
    ds_read_b64_tr_b16 v[90:91], v10 offset:5136
    s_waitcnt lgkmcnt(8)
    v_mfma_f32_16x16x32_bf16 v[64:67], v[104:107], v[112:115], v[64:67]
    v_mfma_f32_16x16x32_bf16 v[68:71], v[104:107], v[116:119], v[68:71]
    ds_read_b64_tr_b16 v[92:93], v9 offset:5144
    ds_read_b64_tr_b16 v[94:95], v10 offset:5144
    s_waitcnt lgkmcnt(8)
    v_mfma_f32_16x16x32_bf16 v[72:75], v[108:111], v[112:115], v[72:75]
    v_mfma_f32_16x16x32_bf16 v[76:79], v[108:111], v[116:119], v[76:79]
    ds_read_b64_tr_b16 v[96:97], v9 offset:5152
    ds_read_b64_tr_b16 v[98:99], v10 offset:5152
    s_waitcnt lgkmcnt(8)
    v_mfma_f32_16x16x32_bf16 v[16:19], v[80:83], v[120:123], v[16:19]
    v_mfma_f32_16x16x32_bf16 v[20:23], v[80:83], v[124:127], v[20:23]
    ds_read_b64_tr_b16 v[100:101], v9 offset:15360
    ds_read_b64_tr_b16 v[102:103], v10 offset:15360
    s_waitcnt lgkmcnt(8)
    v_mfma_f32_16x16x32_bf16 v[24:27], v[84:87], v[120:123], v[24:27]
    v_mfma_f32_16x16x32_bf16 v[28:31], v[84:87], v[124:127], v[28:31]
    ds_read_b64_tr_b16 v[104:105], v9 offset:15368
    ds_read_b64_tr_b16 v[106:107], v10 offset:15368
    s_waitcnt lgkmcnt(8)
    v_mfma_f32_16x16x32_bf16 v[32:35], v[88:91], v[120:123], v[32:35]
    v_mfma_f32_16x16x32_bf16 v[36:39], v[88:91], v[124:127], v[36:39]
    ds_read_b64_tr_b16 v[108:109], v9 offset:15376
    ds_read_b64_tr_b16 v[110:111], v10 offset:15376
    s_waitcnt lgkmcnt(8)
    v_mfma_f32_16x16x32_bf16 v[40:43], v[92:95], v[120:123], v[40:43]
    v_mfma_f32_16x16x32_bf16 v[44:47], v[92:95], v[124:127], v[44:47]
    s_waitcnt lgkmcnt(6)
    v_mfma_f32_16x16x32_bf16 v[48:51], v[96:99], v[120:123], v[48:51]
    v_mfma_f32_16x16x32_bf16 v[52:55], v[96:99], v[124:127], v[52:55]
    s_waitcnt lgkmcnt(4)
    v_mfma_f32_16x16x32_bf16 v[56:59], v[100:103], v[120:123], v[56:59]
    v_mfma_f32_16x16x32_bf16 v[60:63], v[100:103], v[124:127], v[60:63]
    s_waitcnt lgkmcnt(2)
    v_mfma_f32_16x16x32_bf16 v[64:67], v[104:107], v[120:123], v[64:67]
    v_mfma_f32_16x16x32_bf16 v[68:71], v[104:107], v[124:127], v[68:71]
    s_waitcnt lgkmcnt(0)
    v_mfma_f32_16x16x32_bf16 v[72:75], v[108:111], v[120:123], v[72:75]
    v_mfma_f32_16x16x32_bf16 v[76:79], v[108:111], v[124:127], v[76:79]
    s_waitcnt vmcnt(0)
    s_cmp_eq_u32 s20, 0
    s_cbranch_scc0 K1_E01
    s_barrier
    s_cmp_eq_u32 s60, 0
    s_cbranch_scc1 K1_NOREP2_0
    v_and_b32 v11, 15, v0
    v_lshrrev_b32 v12, 4, v0
    v_lshrrev_b32 v13, 2, v11
    v_and_b32 v11, 3, v11
    v_lshl_add_u32 v13, v12, 3, v13
    v_mul_u32_u24 v13, 160, v13
    v_mul_u32_u24 v11, 40, v11
    v_add3_u32 v13, v13, v11, s61
    v_lshlrev_b32 v11, 4, v0
    v_add_u32 v12, 4096, v11
    ds_read_b64_tr_b16 v[204:205], v13 offset:0
    ds_read_b64_tr_b16 v[206:207], v13 offset:640
    ds_read_b64_tr_b16 v[208:209], v13 offset:8
    ds_read_b64_tr_b16 v[210:211], v13 offset:648
    ds_read_b64_tr_b16 v[212:213], v13 offset:16
    ds_read_b64_tr_b16 v[214:215], v13 offset:656
    ds_read_b64_tr_b16 v[216:217], v13 offset:24
    ds_read_b64_tr_b16 v[218:219], v13 offset:664
    ds_read_b64_tr_b16 v[220:221], v13 offset:32
    ds_read_b64_tr_b16 v[222:223], v13 offset:672
    s_waitcnt lgkmcnt(0)
    buffer_store_dwordx4 v[204:207], v11, s[56:59], s62 offen offset:0
    buffer_store_dwordx4 v[208:211], v11, s[56:59], s62 offen offset:1024
    buffer_store_dwordx4 v[212:215], v11, s[56:59], s62 offen offset:2048
    buffer_store_dwordx4 v[216:219], v11, s[56:59], s62 offen offset:3072
    buffer_store_dwordx4 v[220:223], v12, s[56:59], s62 offen
    s_nop 1
K1_NOREP2_0:
    s_lshl_b32 s43, s23, 6
    v_add_u32 v11, s43, v0
    v_lshlrev_b32 v12, 4, v11
    v_add_u32 v12, 141312, v12
    v_cmp_gt_u32 vcc, 256, v11
    s_nop 1
    s_and_saveexec_b64 s[52:53], vcc
    ds_write_b128 v12, v[244:247]
    s_mov_b64 exec, s[52:53]
    s_lshl_b32 s42, s22, 2
    v_add_u32 v14, s42, v2
    v_add_u32 v11, s46, v1
    v_mul_u32_u24 v12, 6144, v14
    v_add_lshl_u32 v5, v12, v11, 4
    v_lshl_add_u32 v12, v14, 11, v11
    v_lshlrev_b32 v6, 2, v12
    s_mul_i32 s42, s23, 3072
    s_xor_b32 s43, s23, 4
    s_mul_i32 s43, s43, 3072
    v_lshlrev_b32 v11, 4, v0
    v_add_u32 v11, 65536, v11
    v_add_u32 v12, s42, v11
    v_add_u32 v13, s43, v11
    ds_write_b128 v12, v[60:63] offset:0
    ds_write_b128 v12, v[68:71] offset:1024
    ds_write_b128 v12, v[76:79] offset:2048
    v_mov_b32 v120, v56
    v_mov_b32 v121, v57
    v_mov_b32 v122, v58
    v_mov_b32 v123, v59
    v_mov_b32 v124, v64
    v_mov_b32 v125, v65
    v_mov_b32 v126, v66
    v_mov_b32 v127, v67
    v_mov_b32 v128, v72
    v_mov_b32 v129, v73
    v_mov_b32 v130, v74
    v_mov_b32 v131, v75
    s_waitcnt lgkmcnt(0)
    s_barrier
    ds_read_b128 v[132:135], v13 offset:0
    ds_read_b128 v[136:139], v13 offset:1024
    v_lshrrev_b32 v11, 2, v1
    v_and_b32 v12, 3, v1
    v_mul_u32_u24 v13, 800, v2
    v_mul_u32_u24 v11, 40, v11
    v_add_u32 v13, v13, v11
    v_mov_b32 v11, 3200
    v_cmp_eq_u32 vcc, v12, v2
    s_nop 1
    v_cndmask_b32 v13, v11, v13, vcc
    v_add_u32 v13, 141312, v13
    ds_read_b64_tr_b16 v[144:145], v13 offset:0
    ds_read_b64_tr_b16 v[146:147], v13 offset:160
    ds_read_b64_tr_b16 v[148:149], v13 offset:320
    ds_read_b64_tr_b16 v[150:151], v13 offset:480
    ds_read_b64_tr_b16 v[152:153], v13 offset:640
    ds_read_b64_tr_b16 v[154:155], v13 offset:8
    ds_read_b64_tr_b16 v[156:157], v13 offset:168
    ds_read_b64_tr_b16 v[158:159], v13 offset:328
    s_waitcnt lgkmcnt(0)
    ds_read_b64_tr_b16 v[160:161], v13 offset:488
    ds_read_b64_tr_b16 v[162:163], v13 offset:648
    ds_read_b64_tr_b16 v[164:165], v13 offset:16
    ds_read_b64_tr_b16 v[166:167], v13 offset:176
    ds_read_b64_tr_b16 v[168:169], v13 offset:336
    ds_read_b64_tr_b16 v[170:171], v13 offset:496
    ds_read_b64_tr_b16 v[172:173], v13 offset:656
    ds_read_b64_tr_b16 v[174:175], v13 offset:24
    s_waitcnt lgkmcnt(0)
    ds_read_b64_tr_b16 v[176:177], v13 offset:184
    ds_read_b64_tr_b16 v[178:179], v13 offset:344
    ds_read_b64_tr_b16 v[180:181], v13 offset:504
    ds_read_b64_tr_b16 v[182:183], v13 offset:664
    ds_read_b64_tr_b16 v[184:185], v13 offset:32
    ds_read_b64_tr_b16 v[186:187], v13 offset:192
    ds_read_b64_tr_b16 v[188:189], v13 offset:352
    ds_read_b64_tr_b16 v[190:191], v13 offset:512
    s_waitcnt lgkmcnt(0)
    ds_read_b64_tr_b16 v[192:193], v13 offset:672
    s_waitcnt lgkmcnt(0)
    s_lshl_b32 s44, s24, 5
    v_add_u32 v11, s44, v1
    v_lshl_add_u32 v11, v2, 7, v11
    v_mul_u32_u24 v7, 48, v11
    v_add_u32 v11, 0, v11
    v_mul_u32_u24 v13, 80, v11
    v_mov_b32 v3, v13
    s_mov_b32 s42, 1051011932
    s_mov_b32 s45, 9437184
    v_mul_f32 v16, s42, v16
    v_mul_f32 v17, s42, v17
    v_mul_f32 v18, s42, v18
    v_mul_f32 v19, s42, v19
    v_mul_f32 v24, s42, v24
    v_mul_f32 v25, s42, v25
    v_mul_f32 v26, s42, v26
    v_mul_f32 v27, s42, v27
    v_mul_f32 v32, s42, v32
    v_mul_f32 v33, s42, v33
    v_mul_f32 v34, s42, v34
    v_mul_f32 v35, s42, v35
    v_mul_f32 v40, s42, v40
    v_mul_f32 v41, s42, v41
    v_mul_f32 v42, s42, v42
    v_mul_f32 v43, s42, v43
    v_mul_f32 v48, s42, v48
    v_mul_f32 v49, s42, v49
    v_mul_f32 v50, s42, v50
    v_mul_f32 v51, s42, v51
    v_mul_f32 v8, v16, v16
    v_fmac_f32 v8, v17, v17
    v_fmac_f32 v8, v18, v18
    v_fmac_f32 v8, v19, v19
    v_fmac_f32 v8, v24, v24
    v_fmac_f32 v8, v25, v25
    v_fmac_f32 v8, v26, v26
    v_fmac_f32 v8, v27, v27
    v_fmac_f32 v8, v32, v32
    v_fmac_f32 v8, v33, v33
    v_fmac_f32 v8, v34, v34
    v_fmac_f32 v8, v35, v35
    v_fmac_f32 v8, v40, v40
    v_fmac_f32 v8, v41, v41
    v_fmac_f32 v8, v42, v42
    v_fmac_f32 v8, v43, v43
    v_fmac_f32 v8, v48, v48
    v_fmac_f32 v8, v49, v49
    v_fmac_f32 v8, v50, v50
    v_fmac_f32 v8, v51, v51
    v_cvt_pk_bf16_f32 v80, v16, v17
    v_cvt_pk_bf16_f32 v81, v18, v19
    v_cvt_pk_bf16_f32 v82, v24, v25
    v_cvt_pk_bf16_f32 v83, v26, v27
    v_cvt_pk_bf16_f32 v84, v32, v33
    v_cvt_pk_bf16_f32 v85, v34, v35
    v_cvt_pk_bf16_f32 v86, v40, v41
    v_cvt_pk_bf16_f32 v87, v42, v43
    v_cvt_pk_bf16_f32 v88, v48, v49
    v_cvt_pk_bf16_f32 v89, v50, v51
    v_mov_b32 v90, 0
    v_mov_b32 v91, 0
    s_mov_b32 s43, 0
    buffer_store_dwordx4 v[80:83], v5, s[56:59], s43 offen offset:0
    s_add_u32 s43, s43, 32768
    buffer_store_dwordx4 v[84:87], v5, s[56:59], s43 offen offset:0
    s_add_u32 s43, s43, 32768
    buffer_store_dwordx4 v[88:91], v5, s[56:59], s43 offen offset:0
    v_sqrt_f32 v8, v8
    s_nop 0
    v_mul_f32 v92, 1065395159, v8
    buffer_store_dword v92, v6, s[56:59], s45 offen offset:0
    v_mul_f32 v20, s42, v20
    v_mul_f32 v21, s42, v21
    v_mul_f32 v22, s42, v22
    v_mul_f32 v23, s42, v23
    v_mul_f32 v28, s42, v28
    v_mul_f32 v29, s42, v29
    v_mul_f32 v30, s42, v30
    v_mul_f32 v31, s42, v31
    v_mul_f32 v36, s42, v36
    v_mul_f32 v37, s42, v37
    v_mul_f32 v38, s42, v38
    v_mul_f32 v39, s42, v39
    v_mul_f32 v44, s42, v44
    v_mul_f32 v45, s42, v45
    v_mul_f32 v46, s42, v46
    v_mul_f32 v47, s42, v47
    v_mul_f32 v52, s42, v52
    v_mul_f32 v53, s42, v53
    v_mul_f32 v54, s42, v54
    v_mul_f32 v55, s42, v55
    v_mul_f32 v8, v20, v20
    v_fmac_f32 v8, v21, v21
    v_fmac_f32 v8, v22, v22
    v_fmac_f32 v8, v23, v23
    v_fmac_f32 v8, v28, v28
    v_fmac_f32 v8, v29, v29
    v_fmac_f32 v8, v30, v30
    v_fmac_f32 v8, v31, v31
    v_fmac_f32 v8, v36, v36
    v_fmac_f32 v8, v37, v37
    v_fmac_f32 v8, v38, v38
    v_fmac_f32 v8, v39, v39
    v_fmac_f32 v8, v44, v44
    v_fmac_f32 v8, v45, v45
    v_fmac_f32 v8, v46, v46
    v_fmac_f32 v8, v47, v47
    v_fmac_f32 v8, v52, v52
    v_fmac_f32 v8, v53, v53
    v_fmac_f32 v8, v54, v54
    v_fmac_f32 v8, v55, v55
    v_cvt_pk_bf16_f32 v100, v20, v21
    v_cvt_pk_bf16_f32 v101, v22, v23
    v_cvt_pk_bf16_f32 v102, v28, v29
    v_cvt_pk_bf16_f32 v103, v30, v31
    v_cvt_pk_bf16_f32 v104, v36, v37
    v_cvt_pk_bf16_f32 v105, v38, v39
    v_cvt_pk_bf16_f32 v106, v44, v45
    v_cvt_pk_bf16_f32 v107, v46, v47
    v_cvt_pk_bf16_f32 v108, v52, v53
    v_cvt_pk_bf16_f32 v109, v54, v55
    v_mov_b32 v110, 0
    v_mov_b32 v111, 0
    s_mov_b32 s43, 0
    buffer_store_dwordx4 v[100:103], v5, s[56:59], s43 offen offset:256
    s_add_u32 s43, s43, 32768
    buffer_store_dwordx4 v[104:107], v5, s[56:59], s43 offen offset:256
    s_add_u32 s43, s43, 32768
    buffer_store_dwordx4 v[108:111], v5, s[56:59], s43 offen offset:256
    v_sqrt_f32 v8, v8
    s_nop 0
    v_mul_f32 v112, 1065395159, v8
    buffer_store_dword v112, v6, s[56:59], s45 offen offset:64
    v_cvt_pk_bf16_f32 v194, v120, v121
    v_cvt_pk_bf16_f32 v195, v122, v123
    v_cvt_pk_bf16_f32 v196, v124, v125
    v_cvt_pk_bf16_f32 v197, v126, v127
    v_cvt_pk_bf16_f32 v198, v128, v129
    v_cvt_pk_bf16_f32 v199, v130, v131
    v_cvt_pk_bf16_f32 v200, v132, v133
    v_cvt_pk_bf16_f32 v201, v134, v135
    v_cvt_pk_bf16_f32 v202, v136, v137
    v_cvt_pk_bf16_f32 v203, v138, v139
    s_waitcnt lgkmcnt(0)
    v_mfma_f32_16x16x32_bf16 v[204:207], v[144:147], v[194:197], 0
    v_mfma_f32_16x16x32_bf16 v[208:211], v[154:157], v[194:197], 0
    v_mfma_f32_16x16x32_bf16 v[212:215], v[164:167], v[194:197], 0
    v_mfma_f32_16x16x32_bf16 v[216:219], v[174:177], v[194:197], 0
    v_mfma_f32_16x16x32_bf16 v[220:223], v[184:187], v[194:197], 0
    v_mfma_f32_16x16x32_bf16 v[204:207], v[148:151], v[198:201], v[204:207]
    v_mfma_f32_16x16x32_bf16 v[208:211], v[158:161], v[198:201], v[208:211]
    v_mfma_f32_16x16x32_bf16 v[212:215], v[168:171], v[198:201], v[212:215]
    v_mfma_f32_16x16x32_bf16 v[216:219], v[178:181], v[198:201], v[216:219]
    v_mfma_f32_16x16x32_bf16 v[220:223], v[188:191], v[198:201], v[220:223]
    v_mfma_f32_16x16x16_bf16 v[204:207], v[152:153], v[202:203], v[204:207]
    v_mfma_f32_16x16x16_bf16 v[208:211], v[162:163], v[202:203], v[208:211]
    v_mfma_f32_16x16x16_bf16 v[212:215], v[172:173], v[202:203], v[212:215]
    v_mfma_f32_16x16x16_bf16 v[216:219], v[182:183], v[202:203], v[216:219]
    v_mfma_f32_16x16x16_bf16 v[220:223], v[192:193], v[202:203], v[220:223]
    s_mov_b32 s45, 1069066811
    s_nop 2
    v_max3_f32 v8, v204, v205, v206
    v_min3_f32 v9, v204, v205, v206
    v_max3_f32 v8, v8, v207, v208
    v_min3_f32 v9, v9, v207, v208
    v_max3_f32 v8, v8, v209, v210
    v_min3_f32 v9, v9, v209, v210
    v_max3_f32 v8, v8, v211, v212
    v_min3_f32 v9, v9, v211, v212
    v_max3_f32 v8, v8, v213, v214
    v_min3_f32 v9, v9, v213, v214
    v_max3_f32 v8, v8, v215, v216
    v_min3_f32 v9, v9, v215, v216
    v_max3_f32 v8, v8, v217, v218
    v_min3_f32 v9, v9, v217, v218
    v_max3_f32 v8, v8, v219, v220
    v_min3_f32 v9, v9, v219, v220
    v_max3_f32 v8, v8, v221, v222
    v_min3_f32 v9, v9, v221, v222
    v_max_f32 v8, v8, v223
    v_min_f32 v9, v9, v223
    v_mul_f32 v8, s45, v8
    v_mul_f32 v9, s45, v9
    v_fma_f32 v224, -v204, s45, v9
    v_fma_f32 v204, v204, s45, -v8
    v_fma_f32 v225, -v205, s45, v9
    v_fma_f32 v205, v205, s45, -v8
    v_fma_f32 v226, -v206, s45, v9
    v_fma_f32 v206, v206, s45, -v8
    v_fma_f32 v227, -v207, s45, v9
    v_fma_f32 v207, v207, s45, -v8
    v_fma_f32 v228, -v208, s45, v9
    v_fma_f32 v208, v208, s45, -v8
    v_fma_f32 v229, -v209, s45, v9
    v_fma_f32 v209, v209, s45, -v8
    v_fma_f32 v230, -v210, s45, v9
    v_fma_f32 v210, v210, s45, -v8
    v_fma_f32 v231, -v211, s45, v9
    v_fma_f32 v211, v211, s45, -v8
    v_fma_f32 v232, -v212, s45, v9
    v_fma_f32 v212, v212, s45, -v8
    v_fma_f32 v233, -v213, s45, v9
    v_fma_f32 v213, v213, s45, -v8
    v_fma_f32 v234, -v214, s45, v9
    v_fma_f32 v214, v214, s45, -v8
    v_fma_f32 v235, -v215, s45, v9
    v_fma_f32 v215, v215, s45, -v8
    v_fma_f32 v236, -v216, s45, v9
    v_fma_f32 v216, v216, s45, -v8
    v_fma_f32 v237, -v217, s45, v9
    v_fma_f32 v217, v217, s45, -v8
    v_fma_f32 v238, -v218, s45, v9
    v_fma_f32 v218, v218, s45, -v8
    v_fma_f32 v239, -v219, s45, v9
    v_fma_f32 v219, v219, s45, -v8
    v_fma_f32 v240, -v220, s45, v9
    v_fma_f32 v220, v220, s45, -v8
    v_fma_f32 v241, -v221, s45, v9
    v_fma_f32 v221, v221, s45, -v8
    v_fma_f32 v242, -v222, s45, v9
    v_fma_f32 v222, v222, s45, -v8
    v_fma_f32 v243, -v223, s45, v9
    v_fma_f32 v223, v223, s45, -v8
    v_exp_f32 v204, v204
    v_exp_f32 v224, v224
    v_exp_f32 v205, v205
    v_exp_f32 v225, v225
    v_exp_f32 v206, v206
    v_exp_f32 v226, v226
    v_exp_f32 v207, v207
    v_exp_f32 v227, v227
    v_exp_f32 v208, v208
    v_exp_f32 v228, v228
    v_exp_f32 v209, v209
    v_exp_f32 v229, v229
    v_exp_f32 v210, v210
    v_exp_f32 v230, v230
    v_exp_f32 v211, v211
    v_exp_f32 v231, v231
    v_exp_f32 v212, v212
    v_exp_f32 v232, v232
    v_exp_f32 v213, v213
    v_exp_f32 v233, v233
    v_exp_f32 v214, v214
    v_exp_f32 v234, v234
    v_exp_f32 v215, v215
    v_exp_f32 v235, v235
    v_exp_f32 v216, v216
    v_exp_f32 v236, v236
    v_exp_f32 v217, v217
    v_exp_f32 v237, v237
    v_exp_f32 v218, v218
    v_exp_f32 v238, v238
    v_exp_f32 v219, v219
    v_exp_f32 v239, v239
    v_exp_f32 v220, v220
    v_exp_f32 v240, v240
    v_exp_f32 v221, v221
    v_exp_f32 v241, v241
    v_exp_f32 v222, v222
    v_exp_f32 v242, v242
    v_exp_f32 v223, v223
    v_exp_f32 v243, v243
    v_add_f32 v8, v204, v205
    v_add_f32 v9, v224, v225
    v_add_f32 v8, v8, v206
    v_add_f32 v9, v9, v226
    v_add_f32 v8, v8, v207
    v_add_f32 v9, v9, v227
    v_add_f32 v8, v8, v208
    v_add_f32 v9, v9, v228
    v_add_f32 v8, v8, v209
    v_add_f32 v9, v9, v229
    v_add_f32 v8, v8, v210
    v_add_f32 v9, v9, v230
    v_add_f32 v8, v8, v211
    v_add_f32 v9, v9, v231
    v_add_f32 v8, v8, v212
    v_add_f32 v9, v9, v232
    v_add_f32 v8, v8, v213
    v_add_f32 v9, v9, v233
    v_add_f32 v8, v8, v214
    v_add_f32 v9, v9, v234
    v_add_f32 v8, v8, v215
    v_add_f32 v9, v9, v235
    v_add_f32 v8, v8, v216
    v_add_f32 v9, v9, v236
    v_add_f32 v8, v8, v217
    v_add_f32 v9, v9, v237
    v_add_f32 v8, v8, v218
    v_add_f32 v9, v9, v238
    v_add_f32 v8, v8, v219
    v_add_f32 v9, v9, v239
    v_add_f32 v8, v8, v220
    v_add_f32 v9, v9, v240
    v_add_f32 v8, v8, v221
    v_add_f32 v9, v9, v241
    v_add_f32 v8, v8, v222
    v_add_f32 v9, v9, v242
    v_add_f32 v8, v8, v223
    v_add_f32 v9, v9, v243
    v_rcp_f32 v8, v8
    v_rcp_f32 v9, v9
    v_mul_f32 v204, v8, v204
    v_mul_f32 v224, v9, v224
    v_mul_f32 v205, v8, v205
    v_mul_f32 v225, v9, v225
    v_mul_f32 v206, v8, v206
    v_mul_f32 v226, v9, v226
    v_mul_f32 v207, v8, v207
    v_mul_f32 v227, v9, v227
    v_mul_f32 v208, v8, v208
    v_mul_f32 v228, v9, v228
    v_mul_f32 v209, v8, v209
    v_mul_f32 v229, v9, v229
    v_mul_f32 v210, v8, v210
    v_mul_f32 v230, v9, v230
    v_mul_f32 v211, v8, v211
    v_mul_f32 v231, v9, v231
    v_mul_f32 v212, v8, v212
    v_mul_f32 v232, v9, v232
    v_mul_f32 v213, v8, v213
    v_mul_f32 v233, v9, v233
    v_mul_f32 v214, v8, v214
    v_mul_f32 v234, v9, v234
    v_mul_f32 v215, v8, v215
    v_mul_f32 v235, v9, v235
    v_mul_f32 v216, v8, v216
    v_mul_f32 v236, v9, v236
    v_mul_f32 v217, v8, v217
    v_mul_f32 v237, v9, v237
    v_mul_f32 v218, v8, v218
    v_mul_f32 v238, v9, v238
    v_mul_f32 v219, v8, v219
    v_mul_f32 v239, v9, v239
    v_mul_f32 v220, v8, v220
    v_mul_f32 v240, v9, v240
    v_mul_f32 v221, v8, v221
    v_mul_f32 v241, v9, v241
    v_mul_f32 v222, v8, v222
    v_mul_f32 v242, v9, v242
    v_mul_f32 v223, v8, v223
    v_mul_f32 v243, v9, v243
    v_cvt_pk_bf16_f32 v80, v204, v205
    v_cvt_pk_bf16_f32 v90, v224, v225
    v_cvt_pk_bf16_f32 v81, v206, v207
    v_cvt_pk_bf16_f32 v91, v226, v227
    v_cvt_pk_bf16_f32 v82, v208, v209
    v_cvt_pk_bf16_f32 v92, v228, v229
    v_cvt_pk_bf16_f32 v83, v210, v211
    v_cvt_pk_bf16_f32 v93, v230, v231
    v_cvt_pk_bf16_f32 v84, v212, v213
    v_cvt_pk_bf16_f32 v94, v232, v233
    v_cvt_pk_bf16_f32 v85, v214, v215
    v_cvt_pk_bf16_f32 v95, v234, v235
    v_cvt_pk_bf16_f32 v86, v216, v217
    v_cvt_pk_bf16_f32 v96, v236, v237
    v_cvt_pk_bf16_f32 v87, v218, v219
    v_cvt_pk_bf16_f32 v97, v238, v239
    v_cvt_pk_bf16_f32 v88, v220, v221
    v_cvt_pk_bf16_f32 v98, v240, v241
    v_cvt_pk_bf16_f32 v89, v222, v223
    v_cvt_pk_bf16_f32 v99, v242, v243
    ds_write_b128 v3, v[80:83] offset:0
    ds_write_b128 v3, v[84:87] offset:16
    ds_write_b128 v3, v[88:91] offset:32
    ds_write_b128 v3, v[92:95] offset:48
    ds_write_b128 v3, v[96:99] offset:64
    s_waitcnt lgkmcnt(0)
    s_barrier
    v_lshrrev_b32 v11, 2, v1
    v_and_b32 v12, 3, v1
    v_lshl_add_u32 v11, v2, 3, v11
    s_lshl_b32 s44, s24, 7
    v_add_u32 v11, s44, v11
    v_mul_u32_u24 v13, 80, v11
    v_lshl_add_u32 v13, v12, 3, v13
    v_mul_u32_u24 v15, 48, v11
    v_lshl_add_u32 v15, v12, 3, v15
    s_lshl_b32 s44, s25, 5
    v_add_u32 v15, s44, v15
    ds_read_b64_tr_b16 v[32:33], v13 offset:0
    ds_read_b64_tr_b16 v[34:35], v13 offset:320
    ds_read_b64_tr_b16 v[36:37], v13 offset:32
    ds_read_b64_tr_b16 v[38:39], v13 offset:352
    ds_read_b64_tr_b16 v[40:41], v13 offset:64
    ds_read_b64_tr_b16 v[42:43], v13 offset:384
    ds_read_b64_tr_b16 v[44:45], v15 offset:40960
    ds_read_b64_tr_b16 v[46:47], v15 offset:41152
    s_waitcnt lgkmcnt(1)
    ds_read_b64_tr_b16 v[48:49], v13 offset:2560
    ds_read_b64_tr_b16 v[50:51], v13 offset:2880
    ds_read_b64_tr_b16 v[52:53], v13 offset:2592
    ds_read_b64_tr_b16 v[54:55], v13 offset:2912
    ds_read_b64_tr_b16 v[56:57], v13 offset:2624
    ds_read_b64_tr_b16 v[58:59], v13 offset:2944
    ds_read_b64_tr_b16 v[60:61], v15 offset:42496
    ds_read_b64_tr_b16 v[62:63], v15 offset:42688
    s_waitcnt lgkmcnt(8)
    v_mfma_f32_16x16x32_bf16 v[16:19], v[32:35], v[44:47], 0
    v_mfma_f32_16x16x32_bf16 v[20:23], v[36:39], v[44:47], 0
    v_mfma_f32_16x16x32_bf16 v[24:27], v[40:43], v[44:47], 0
    s_waitcnt lgkmcnt(1)
    ds_read_b64_tr_b16 v[64:65], v13 offset:5120
    ds_read_b64_tr_b16 v[66:67], v13 offset:5440
    ds_read_b64_tr_b16 v[68:69], v13 offset:5152
    ds_read_b64_tr_b16 v[70:71], v13 offset:5472
    ds_read_b64_tr_b16 v[72:73], v13 offset:5184
    ds_read_b64_tr_b16 v[74:75], v13 offset:5504
    ds_read_b64_tr_b16 v[76:77], v15 offset:44032
    ds_read_b64_tr_b16 v[78:79], v15 offset:44224
    s_waitcnt lgkmcnt(8)
    v_mfma_f32_16x16x32_bf16 v[16:19], v[48:51], v[60:63], v[16:19]
    v_mfma_f32_16x16x32_bf16 v[20:23], v[52:55], v[60:63], v[20:23]
    v_mfma_f32_16x16x32_bf16 v[24:27], v[56:59], v[60:63], v[24:27]
    s_waitcnt lgkmcnt(1)
    ds_read_b64_tr_b16 v[80:81], v13 offset:7680
    ds_read_b64_tr_b16 v[82:83], v13 offset:8000
    ds_read_b64_tr_b16 v[84:85], v13 offset:7712
    ds_read_b64_tr_b16 v[86:87], v13 offset:8032
    ds_read_b64_tr_b16 v[88:89], v13 offset:7744
    ds_read_b64_tr_b16 v[90:91], v13 offset:8064
    ds_read_b64_tr_b16 v[92:93], v15 offset:45568
    ds_read_b64_tr_b16 v[94:95], v15 offset:45760
    s_waitcnt lgkmcnt(8)
    v_mfma_f32_16x16x32_bf16 v[16:19], v[64:67], v[76:79], v[16:19]
    v_mfma_f32_16x16x32_bf16 v[20:23], v[68:71], v[76:79], v[20:23]
    v_mfma_f32_16x16x32_bf16 v[24:27], v[72:75], v[76:79], v[24:27]
    s_waitcnt lgkmcnt(0)
    v_mfma_f32_16x16x32_bf16 v[16:19], v[80:83], v[92:95], v[16:19]
    v_mfma_f32_16x16x32_bf16 v[20:23], v[84:87], v[92:95], v[20:23]
    v_mfma_f32_16x16x32_bf16 v[24:27], v[88:91], v[92:95], v[24:27]
    s_lshl_b32 s42, s22, 2
    s_add_u32 s42, s42, s24
    s_lshl_b32 s42, s42, 4
    s_add_u32 s42, s42, s21
    s_mul_i32 s42, s42, 3360
    s_add_u32 s42, s42, 14966784
    s_lshl_b32 s44, s25, 4
    v_add_u32 v12, s44, v1
    v_mul_u32_u24 v11, 160, v12
    v_lshl_add_u32 v11, v2, 4, v11
    v_cmp_gt_u32 s[52:53], 21, v12
    v_cmp_gt_u32 s[54:55], 2, v2
    s_nop 1
    s_and_b64 s[54:55], s[52:53], s[54:55]
    s_mov_b64 exec, s[52:53]
    buffer_store_dwordx4 v[16:19], v11, s[56:59], s42 offen offset:0
    s_mov_b64 exec, s[52:53]
    buffer_store_dwordx4 v[20:23], v11, s[56:59], s42 offen offset:64
    s_mov_b64 exec, s[54:55]
    buffer_store_dwordx4 v[24:27], v11, s[56:59], s42 offen offset:128
    s_mov_b64 exec, -1
    s_branch K1_FIN
K1_E01:
    s_barrier
    s_cmp_eq_u32 s60, 0
    s_cbranch_scc1 K1_NOREP2_1
    v_and_b32 v11, 15, v0
    v_lshrrev_b32 v12, 4, v0
    v_lshrrev_b32 v13, 2, v11
    v_and_b32 v11, 3, v11
    v_lshl_add_u32 v13, v12, 3, v13
    v_mul_u32_u24 v13, 160, v13
    v_mul_u32_u24 v11, 40, v11
    v_add3_u32 v13, v13, v11, s61
    v_lshlrev_b32 v11, 4, v0
    v_add_u32 v12, 4096, v11
    ds_read_b64_tr_b16 v[204:205], v13 offset:0
    ds_read_b64_tr_b16 v[206:207], v13 offset:640
    ds_read_b64_tr_b16 v[208:209], v13 offset:8
    ds_read_b64_tr_b16 v[210:211], v13 offset:648
    ds_read_b64_tr_b16 v[212:213], v13 offset:16
    ds_read_b64_tr_b16 v[214:215], v13 offset:656
    ds_read_b64_tr_b16 v[216:217], v13 offset:24
    ds_read_b64_tr_b16 v[218:219], v13 offset:664
    ds_read_b64_tr_b16 v[220:221], v13 offset:32
    ds_read_b64_tr_b16 v[222:223], v13 offset:672
    s_waitcnt lgkmcnt(0)
    buffer_store_dwordx4 v[204:207], v11, s[56:59], s62 offen offset:0
    buffer_store_dwordx4 v[208:211], v11, s[56:59], s62 offen offset:1024
    buffer_store_dwordx4 v[212:215], v11, s[56:59], s62 offen offset:2048
    buffer_store_dwordx4 v[216:219], v11, s[56:59], s62 offen offset:3072
    buffer_store_dwordx4 v[220:223], v12, s[56:59], s62 offen
    s_nop 1
K1_NOREP2_1:
    s_lshl_b32 s43, s23, 6
    v_add_u32 v11, s43, v0
    v_lshlrev_b32 v12, 4, v11
    v_add_u32 v12, 141312, v12
    v_cmp_gt_u32 vcc, 256, v11
    s_nop 1
    s_and_saveexec_b64 s[52:53], vcc
    ds_write_b128 v12, v[244:247]
    s_mov_b64 exec, s[52:53]
    s_lshl_b32 s42, s22, 2
    v_add_u32 v14, s42, v2
    v_add_u32 v11, s46, v1
    v_mul_u32_u24 v12, 6144, v14
    v_add_lshl_u32 v5, v12, v11, 4
    v_lshl_add_u32 v12, v14, 11, v11
    v_lshlrev_b32 v6, 2, v12
    s_mul_i32 s42, s23, 3072
    s_xor_b32 s43, s23, 4
    s_mul_i32 s43, s43, 3072
    v_lshlrev_b32 v11, 4, v0
    v_add_u32 v11, 65536, v11
    v_add_u32 v12, s42, v11
    v_add_u32 v13, s43, v11
    ds_write_b128 v12, v[60:63] offset:0
    ds_write_b128 v12, v[68:71] offset:1024
    ds_write_b128 v12, v[76:79] offset:2048
    v_mov_b32 v120, v56
    v_mov_b32 v121, v57
    v_mov_b32 v122, v58
    v_mov_b32 v123, v59
    v_mov_b32 v124, v64
    v_mov_b32 v125, v65
    v_mov_b32 v126, v66
    v_mov_b32 v127, v67
    v_mov_b32 v128, v72
    v_mov_b32 v129, v73
    v_mov_b32 v130, v74
    v_mov_b32 v131, v75
    s_waitcnt lgkmcnt(0)
    s_barrier
    ds_read_b128 v[132:135], v13 offset:0
    ds_read_b128 v[136:139], v13 offset:1024
    v_lshrrev_b32 v11, 2, v1
    v_and_b32 v12, 3, v1
    v_mul_u32_u24 v13, 800, v2
    v_mul_u32_u24 v11, 40, v11
    v_add_u32 v13, v13, v11
    v_mov_b32 v11, 3200
    v_cmp_eq_u32 vcc, v12, v2
    s_nop 1
    v_cndmask_b32 v13, v11, v13, vcc
    v_add_u32 v13, 141312, v13
    ds_read_b64_tr_b16 v[144:145], v13 offset:0
    ds_read_b64_tr_b16 v[146:147], v13 offset:160
    ds_read_b64_tr_b16 v[148:149], v13 offset:320
    ds_read_b64_tr_b16 v[150:151], v13 offset:480
    ds_read_b64_tr_b16 v[152:153], v13 offset:640
    ds_read_b64_tr_b16 v[154:155], v13 offset:8
    ds_read_b64_tr_b16 v[156:157], v13 offset:168
    ds_read_b64_tr_b16 v[158:159], v13 offset:328
    s_waitcnt lgkmcnt(0)
    ds_read_b64_tr_b16 v[160:161], v13 offset:488
    ds_read_b64_tr_b16 v[162:163], v13 offset:648
    ds_read_b64_tr_b16 v[164:165], v13 offset:16
    ds_read_b64_tr_b16 v[166:167], v13 offset:176
    ds_read_b64_tr_b16 v[168:169], v13 offset:336
    ds_read_b64_tr_b16 v[170:171], v13 offset:496
    ds_read_b64_tr_b16 v[172:173], v13 offset:656
    ds_read_b64_tr_b16 v[174:175], v13 offset:24
    s_waitcnt lgkmcnt(0)
    ds_read_b64_tr_b16 v[176:177], v13 offset:184
    ds_read_b64_tr_b16 v[178:179], v13 offset:344
    ds_read_b64_tr_b16 v[180:181], v13 offset:504
    ds_read_b64_tr_b16 v[182:183], v13 offset:664
    ds_read_b64_tr_b16 v[184:185], v13 offset:32
    ds_read_b64_tr_b16 v[186:187], v13 offset:192
    ds_read_b64_tr_b16 v[188:189], v13 offset:352
    ds_read_b64_tr_b16 v[190:191], v13 offset:512
    s_waitcnt lgkmcnt(0)
    ds_read_b64_tr_b16 v[192:193], v13 offset:672
    s_waitcnt lgkmcnt(0)
    v_mul_f32 v7, v16, v16
    v_fmac_f32 v7, v17, v17
    v_fmac_f32 v7, v18, v18
    v_fmac_f32 v7, v19, v19
    v_fmac_f32 v7, v24, v24
    v_fmac_f32 v7, v25, v25
    v_fmac_f32 v7, v26, v26
    v_fmac_f32 v7, v27, v27
    v_fmac_f32 v7, v32, v32
    v_fmac_f32 v7, v33, v33
    v_fmac_f32 v7, v34, v34
    v_fmac_f32 v7, v35, v35
    v_fmac_f32 v7, v40, v40
    v_fmac_f32 v7, v41, v41
    v_fmac_f32 v7, v42, v42
    v_fmac_f32 v7, v43, v43
    v_fmac_f32 v7, v48, v48
    v_fmac_f32 v7, v49, v49
    v_fmac_f32 v7, v50, v50
    v_fmac_f32 v7, v51, v51
    v_cvt_pk_bf16_f32 v80, v16, v17
    v_cvt_pk_bf16_f32 v81, v18, v19
    v_cvt_pk_bf16_f32 v82, v24, v25
    v_cvt_pk_bf16_f32 v83, v26, v27
    v_cvt_pk_bf16_f32 v84, v32, v33
    v_cvt_pk_bf16_f32 v85, v34, v35
    v_cvt_pk_bf16_f32 v86, v40, v41
    v_cvt_pk_bf16_f32 v87, v42, v43
    v_cvt_pk_bf16_f32 v88, v48, v49
    v_cvt_pk_bf16_f32 v89, v50, v51
    v_mov_b32 v90, 0x3f80
    v_mov_b32 v91, 0
    s_mov_b32 s43, 3145728
    buffer_store_dwordx4 v[80:83], v5, s[56:59], s43 offen offset:0
    s_add_u32 s43, s43, 32768
    buffer_store_dwordx4 v[84:87], v5, s[56:59], s43 offen offset:0
    s_add_u32 s43, s43, 32768
    buffer_store_dwordx4 v[88:91], v5, s[56:59], s43 offen offset:0
    v_mul_f32 v8, v20, v20
    v_fmac_f32 v8, v21, v21
    v_fmac_f32 v8, v22, v22
    v_fmac_f32 v8, v23, v23
    v_fmac_f32 v8, v28, v28
    v_fmac_f32 v8, v29, v29
    v_fmac_f32 v8, v30, v30
    v_fmac_f32 v8, v31, v31
    v_fmac_f32 v8, v36, v36
    v_fmac_f32 v8, v37, v37
    v_fmac_f32 v8, v38, v38
    v_fmac_f32 v8, v39, v39
    v_fmac_f32 v8, v44, v44
    v_fmac_f32 v8, v45, v45
    v_fmac_f32 v8, v46, v46
    v_fmac_f32 v8, v47, v47
    v_fmac_f32 v8, v52, v52
    v_fmac_f32 v8, v53, v53
    v_fmac_f32 v8, v54, v54
    v_fmac_f32 v8, v55, v55
    v_cvt_pk_bf16_f32 v100, v20, v21
    v_cvt_pk_bf16_f32 v101, v22, v23
    v_cvt_pk_bf16_f32 v102, v28, v29
    v_cvt_pk_bf16_f32 v103, v30, v31
    v_cvt_pk_bf16_f32 v104, v36, v37
    v_cvt_pk_bf16_f32 v105, v38, v39
    v_cvt_pk_bf16_f32 v106, v44, v45
    v_cvt_pk_bf16_f32 v107, v46, v47
    v_cvt_pk_bf16_f32 v108, v52, v53
    v_cvt_pk_bf16_f32 v109, v54, v55
    v_mov_b32 v110, 0x3f80
    v_mov_b32 v111, 0
    s_mov_b32 s43, 3145728
    buffer_store_dwordx4 v[100:103], v5, s[56:59], s43 offen offset:256
    s_add_u32 s43, s43, 32768
    buffer_store_dwordx4 v[104:107], v5, s[56:59], s43 offen offset:256
    s_add_u32 s43, s43, 32768
    buffer_store_dwordx4 v[108:111], v5, s[56:59], s43 offen offset:256
    v_max_f32 v7, v7, v8
    s_nop 1
    v_max_f32_dpp v7, v7, v7 row_ror:8 row_mask:0xf bank_mask:0xf
    s_nop 1
    v_max_f32_dpp v7, v7, v7 row_ror:4 row_mask:0xf bank_mask:0xf
    s_nop 1
    v_max_f32_dpp v7, v7, v7 row_ror:2 row_mask:0xf bank_mask:0xf
    s_nop 1
    v_max_f32_dpp v7, v7, v7 row_ror:1 row_mask:0xf bank_mask:0xf
    v_mul_f32 v7, 1065437102, v7
    s_lshl_b32 s42, s21, 2
    s_add_u32 s42, s42, s24
    s_lshl_b32 s42, s42, 2
    s_add_u32 s42, s42, 9699328
    v_lshlrev_b32 v11, 8, v14
    v_cmp_eq_u32 vcc, 0, v1
    s_nop 1
    s_and_saveexec_b64 s[52:53], vcc
    buffer_store_dword v7, v11, s[56:59], s42 offen
    s_mov_b64 exec, s[52:53]
    v_cvt_pk_bf16_f32 v194, v120, v121
    v_cvt_pk_bf16_f32 v195, v122, v123
    v_cvt_pk_bf16_f32 v196, v124, v125
    v_cvt_pk_bf16_f32 v197, v126, v127
    v_cvt_pk_bf16_f32 v198, v128, v129
    v_cvt_pk_bf16_f32 v199, v130, v131
    v_cvt_pk_bf16_f32 v200, v132, v133
    v_cvt_pk_bf16_f32 v201, v134, v135
    v_cvt_pk_bf16_f32 v202, v136, v137
    v_cvt_pk_bf16_f32 v203, v138, v139
    s_waitcnt lgkmcnt(0)
    v_mfma_f32_16x16x32_bf16 v[204:207], v[144:147], v[194:197], 0
    v_mfma_f32_16x16x32_bf16 v[208:211], v[154:157], v[194:197], 0
    v_mfma_f32_16x16x32_bf16 v[212:215], v[164:167], v[194:197], 0
    v_mfma_f32_16x16x32_bf16 v[216:219], v[174:177], v[194:197], 0
    v_mfma_f32_16x16x32_bf16 v[220:223], v[184:187], v[194:197], 0
    v_mfma_f32_16x16x32_bf16 v[204:207], v[148:151], v[198:201], v[204:207]
    v_mfma_f32_16x16x32_bf16 v[208:211], v[158:161], v[198:201], v[208:211]
    v_mfma_f32_16x16x32_bf16 v[212:215], v[168:171], v[198:201], v[212:215]
    v_mfma_f32_16x16x32_bf16 v[216:219], v[178:181], v[198:201], v[216:219]
    v_mfma_f32_16x16x32_bf16 v[220:223], v[188:191], v[198:201], v[220:223]
    v_mfma_f32_16x16x16_bf16 v[204:207], v[152:153], v[202:203], v[204:207]
    v_mfma_f32_16x16x16_bf16 v[208:211], v[162:163], v[202:203], v[208:211]
    v_mfma_f32_16x16x16_bf16 v[212:215], v[172:173], v[202:203], v[212:215]
    v_mfma_f32_16x16x16_bf16 v[216:219], v[182:183], v[202:203], v[216:219]
    v_mfma_f32_16x16x16_bf16 v[220:223], v[192:193], v[202:203], v[220:223]
    s_mov_b32 s45, 1069066811
    s_nop 2
    v_max3_f32 v8, v204, v205, v206
    v_min3_f32 v9, v204, v205, v206
    v_max3_f32 v8, v8, v207, v208
    v_min3_f32 v9, v9, v207, v208
    v_max3_f32 v8, v8, v209, v210
    v_min3_f32 v9, v9, v209, v210
    v_max3_f32 v8, v8, v211, v212
    v_min3_f32 v9, v9, v211, v212
    v_max3_f32 v8, v8, v213, v214
    v_min3_f32 v9, v9, v213, v214
    v_max3_f32 v8, v8, v215, v216
    v_min3_f32 v9, v9, v215, v216
    v_max3_f32 v8, v8, v217, v218
    v_min3_f32 v9, v9, v217, v218
    v_max3_f32 v8, v8, v219, v220
    v_min3_f32 v9, v9, v219, v220
    v_max3_f32 v8, v8, v221, v222
    v_min3_f32 v9, v9, v221, v222
    v_max_f32 v8, v8, v223
    v_min_f32 v9, v9, v223
    v_mul_f32 v8, s45, v8
    v_mul_f32 v9, s45, v9
    v_fma_f32 v224, -v204, s45, v9
    v_fma_f32 v204, v204, s45, -v8
    v_fma_f32 v225, -v205, s45, v9
    v_fma_f32 v205, v205, s45, -v8
    v_fma_f32 v226, -v206, s45, v9
    v_fma_f32 v206, v206, s45, -v8
    v_fma_f32 v227, -v207, s45, v9
    v_fma_f32 v207, v207, s45, -v8
    v_fma_f32 v228, -v208, s45, v9
    v_fma_f32 v208, v208, s45, -v8
    v_fma_f32 v229, -v209, s45, v9
    v_fma_f32 v209, v209, s45, -v8
    v_fma_f32 v230, -v210, s45, v9
    v_fma_f32 v210, v210, s45, -v8
    v_fma_f32 v231, -v211, s45, v9
    v_fma_f32 v211, v211, s45, -v8
    v_fma_f32 v232, -v212, s45, v9
    v_fma_f32 v212, v212, s45, -v8
    v_fma_f32 v233, -v213, s45, v9
    v_fma_f32 v213, v213, s45, -v8
    v_fma_f32 v234, -v214, s45, v9
    v_fma_f32 v214, v214, s45, -v8
    v_fma_f32 v235, -v215, s45, v9
    v_fma_f32 v215, v215, s45, -v8
    v_fma_f32 v236, -v216, s45, v9
    v_fma_f32 v216, v216, s45, -v8
    v_fma_f32 v237, -v217, s45, v9
    v_fma_f32 v217, v217, s45, -v8
    v_fma_f32 v238, -v218, s45, v9
    v_fma_f32 v218, v218, s45, -v8
    v_fma_f32 v239, -v219, s45, v9
    v_fma_f32 v219, v219, s45, -v8
    v_fma_f32 v240, -v220, s45, v9
    v_fma_f32 v220, v220, s45, -v8
    v_fma_f32 v241, -v221, s45, v9
    v_fma_f32 v221, v221, s45, -v8
    v_fma_f32 v242, -v222, s45, v9
    v_fma_f32 v222, v222, s45, -v8
    v_fma_f32 v243, -v223, s45, v9
    v_fma_f32 v223, v223, s45, -v8
    v_exp_f32 v204, v204
    v_exp_f32 v224, v224
    v_exp_f32 v205, v205
    v_exp_f32 v225, v225
    v_exp_f32 v206, v206
    v_exp_f32 v226, v226
    v_exp_f32 v207, v207
    v_exp_f32 v227, v227
    v_exp_f32 v208, v208
    v_exp_f32 v228, v228
    v_exp_f32 v209, v209
    v_exp_f32 v229, v229
    v_exp_f32 v210, v210
    v_exp_f32 v230, v230
    v_exp_f32 v211, v211
    v_exp_f32 v231, v231
    v_exp_f32 v212, v212
    v_exp_f32 v232, v232
    v_exp_f32 v213, v213
    v_exp_f32 v233, v233
    v_exp_f32 v214, v214
    v_exp_f32 v234, v234
    v_exp_f32 v215, v215
    v_exp_f32 v235, v235
    v_exp_f32 v216, v216
    v_exp_f32 v236, v236
    v_exp_f32 v217, v217
    v_exp_f32 v237, v237
    v_exp_f32 v218, v218
    v_exp_f32 v238, v238
    v_exp_f32 v219, v219
    v_exp_f32 v239, v239
    v_exp_f32 v220, v220
    v_exp_f32 v240, v240
    v_exp_f32 v221, v221
    v_exp_f32 v241, v241
    v_exp_f32 v222, v222
    v_exp_f32 v242, v242
    v_exp_f32 v223, v223
    v_exp_f32 v243, v243
    v_add_f32 v8, v204, v205
    v_add_f32 v9, v224, v225
    v_add_f32 v8, v8, v206
    v_add_f32 v9, v9, v226
    v_add_f32 v8, v8, v207
    v_add_f32 v9, v9, v227
    v_add_f32 v8, v8, v208
    v_add_f32 v9, v9, v228
    v_add_f32 v8, v8, v209
    v_add_f32 v9, v9, v229
    v_add_f32 v8, v8, v210
    v_add_f32 v9, v9, v230
    v_add_f32 v8, v8, v211
    v_add_f32 v9, v9, v231
    v_add_f32 v8, v8, v212
    v_add_f32 v9, v9, v232
    v_add_f32 v8, v8, v213
    v_add_f32 v9, v9, v233
    v_add_f32 v8, v8, v214
    v_add_f32 v9, v9, v234
    v_add_f32 v8, v8, v215
    v_add_f32 v9, v9, v235
    v_add_f32 v8, v8, v216
    v_add_f32 v9, v9, v236
    v_add_f32 v8, v8, v217
    v_add_f32 v9, v9, v237
    v_add_f32 v8, v8, v218
    v_add_f32 v9, v9, v238
    v_add_f32 v8, v8, v219
    v_add_f32 v9, v9, v239
    v_add_f32 v8, v8, v220
    v_add_f32 v9, v9, v240
    v_add_f32 v8, v8, v221
    v_add_f32 v9, v9, v241
    v_add_f32 v8, v8, v222
    v_add_f32 v9, v9, v242
    v_add_f32 v8, v8, v223
    v_add_f32 v9, v9, v243
    v_rcp_f32 v8, v8
    v_rcp_f32 v9, v9
    v_mul_f32 v204, v8, v204
    v_mul_f32 v224, v9, v224
    v_mul_f32 v205, v8, v205
    v_mul_f32 v225, v9, v225
    v_mul_f32 v206, v8, v206
    v_mul_f32 v226, v9, v226
    v_mul_f32 v207, v8, v207
    v_mul_f32 v227, v9, v227
    v_mul_f32 v208, v8, v208
    v_mul_f32 v228, v9, v228
    v_mul_f32 v209, v8, v209
    v_mul_f32 v229, v9, v229
    v_mul_f32 v210, v8, v210
    v_mul_f32 v230, v9, v230
    v_mul_f32 v211, v8, v211
    v_mul_f32 v231, v9, v231
    v_mul_f32 v212, v8, v212
    v_mul_f32 v232, v9, v232
    v_mul_f32 v213, v8, v213
    v_mul_f32 v233, v9, v233
    v_mul_f32 v214, v8, v214
    v_mul_f32 v234, v9, v234
    v_mul_f32 v215, v8, v215
    v_mul_f32 v235, v9, v235
    v_mul_f32 v216, v8, v216
    v_mul_f32 v236, v9, v236
    v_mul_f32 v217, v8, v217
    v_mul_f32 v237, v9, v237
    v_mul_f32 v218, v8, v218
    v_mul_f32 v238, v9, v238
    v_mul_f32 v219, v8, v219
    v_mul_f32 v239, v9, v239
    v_mul_f32 v220, v8, v220
    v_mul_f32 v240, v9, v240
    v_mul_f32 v221, v8, v221
    v_mul_f32 v241, v9, v241
    v_mul_f32 v222, v8, v222
    v_mul_f32 v242, v9, v242
    v_mul_f32 v223, v8, v223
    v_mul_f32 v243, v9, v243
    v_cvt_pk_bf16_f32 v80, v204, v205
    v_cvt_pk_bf16_f32 v90, v224, v225
    v_cvt_pk_bf16_f32 v81, v206, v207
    v_cvt_pk_bf16_f32 v91, v226, v227
    v_cvt_pk_bf16_f32 v82, v208, v209
    v_cvt_pk_bf16_f32 v92, v228, v229
    v_cvt_pk_bf16_f32 v83, v210, v211
    v_cvt_pk_bf16_f32 v93, v230, v231
    v_cvt_pk_bf16_f32 v84, v212, v213
    v_cvt_pk_bf16_f32 v94, v232, v233
    v_cvt_pk_bf16_f32 v85, v214, v215
    v_cvt_pk_bf16_f32 v95, v234, v235
    v_cvt_pk_bf16_f32 v86, v216, v217
    v_cvt_pk_bf16_f32 v96, v236, v237
    v_cvt_pk_bf16_f32 v87, v218, v219
    v_cvt_pk_bf16_f32 v97, v238, v239
    v_cvt_pk_bf16_f32 v88, v220, v221
    v_cvt_pk_bf16_f32 v98, v240, v241
    v_cvt_pk_bf16_f32 v89, v222, v223
    v_cvt_pk_bf16_f32 v99, v242, v243
    v_add_u32 v11, s46, v1
    v_add_u32 v11, 0, v11
    v_mul_u32_u24 v12, 10240, v14
    v_add_lshl_u32 v7, v12, v11, 4
    s_mov_b32 s43, 9723904
    buffer_store_dwordx4 v[80:83], v7, s[56:59], s43 offen offset:0
    s_add_u32 s43, s43, 32768
    buffer_store_dwordx4 v[84:87], v7, s[56:59], s43 offen offset:0
    s_add_u32 s43, s43, 32768
    buffer_store_dwordx4 v[88:91], v7, s[56:59], s43 offen offset:0
    s_add_u32 s43, s43, 32768
    buffer_store_dwordx4 v[92:95], v7, s[56:59], s43 offen offset:0
    s_add_u32 s43, s43, 32768
    buffer_store_dwordx4 v[96:99], v7, s[56:59], s43 offen offset:0
    s_branch K1_FIN
K1_M1:
    ds_read_b128 v[112:115], v15
    ds_read_b128 v[116:119], v15 offset:2048
    ds_read_b128 v[120:123], v166
    ds_read_b128 v[124:127], v166 offset:2048
    ds_read_b64_tr_b16 v[80:81], v9 offset:10264
    ds_read_b64_tr_b16 v[82:83], v10 offset:10264
    ds_read_b64_tr_b16 v[84:85], v9 offset:10272
    ds_read_b64_tr_b16 v[86:87], v10 offset:10272
    ds_read_b64_tr_b16 v[88:89], v9 offset:20480
    ds_read_b64_tr_b16 v[90:91], v10 offset:20480
    ds_read_b64_tr_b16 v[92:93], v9 offset:20488
    ds_read_b64_tr_b16 v[94:95], v10 offset:20488
    ds_read_b64_tr_b16 v[96:97], v9 offset:20496
    ds_read_b64_tr_b16 v[98:99], v10 offset:20496
    s_mov_b32 s26, 3
K1_LOOP1:
    s_barrier
    s_waitcnt lgkmcnt(8)
    v_mfma_f32_16x16x32_bf16 v[16:19], v[80:83], v[112:115], v[16:19]
    v_mfma_f32_16x16x32_bf16 v[20:23], v[80:83], v[116:119], v[20:23]
    ds_read_b64_tr_b16 v[100:101], v9 offset:20504
    ds_read_b64_tr_b16 v[102:103], v10 offset:20504
    s_add_u32 m0, s84, 94208
    s_nop 0
    buffer_load_dwordx4 v7, s[4:7], s87 offen lds
    s_waitcnt lgkmcnt(8)
    v_mfma_f32_16x16x32_bf16 v[24:27], v[84:87], v[112:115], v[24:27]
    v_mfma_f32_16x16x32_bf16 v[28:31], v[84:87], v[116:119], v[28:31]
    ds_read_b64_tr_b16 v[104:105], v9 offset:20512
    ds_read_b64_tr_b16 v[106:107], v10 offset:20512
    s_add_u32 m0, s85, 94208
    s_nop 0
    buffer_load_dwordx4 v8, s[4:7], s87 offen lds
    s_waitcnt lgkmcnt(8)
    v_mfma_f32_16x16x32_bf16 v[32:35], v[88:91], v[112:115], v[32:35]
    v_mfma_f32_16x16x32_bf16 v[36:39], v[88:91], v[116:119], v[36:39]
    ds_read_b64_tr_b16 v[108:109], v9 offset:20512
    ds_read_b64_tr_b16 v[110:111], v10 offset:20512
    s_add_u32 m0, s80, 94208
    s_nop 0
    buffer_load_dwordx4 v3, s[64:67], s86 offen lds
    s_waitcnt lgkmcnt(8)
    v_mfma_f32_16x16x32_bf16 v[40:43], v[92:95], v[112:115], v[40:43]
    v_mfma_f32_16x16x32_bf16 v[44:47], v[92:95], v[116:119], v[44:47]
    ds_read_b64_tr_b16 v[80:81], v9 offset:15384
    ds_read_b64_tr_b16 v[82:83], v10 offset:15384
    s_add_u32 m0, s81, 94208
    s_nop 0
    buffer_load_dwordx4 v4, s[68:71], s86 offen lds
    s_waitcnt lgkmcnt(8)
    v_mfma_f32_16x16x32_bf16 v[48:51], v[96:99], v[112:115], v[48:51]
    v_mfma_f32_16x16x32_bf16 v[52:55], v[96:99], v[116:119], v[52:55]
    ds_read_b64_tr_b16 v[84:85], v9 offset:15392
    ds_read_b64_tr_b16 v[86:87], v10 offset:15392
    s_add_u32 m0, s82, 94208
    s_nop 0
    buffer_load_dwordx4 v5, s[72:75], s86 offen lds
    s_waitcnt lgkmcnt(8)
    v_mfma_f32_16x16x32_bf16 v[56:59], v[100:103], v[112:115], v[56:59]
    v_mfma_f32_16x16x32_bf16 v[60:63], v[100:103], v[116:119], v[60:63]
    ds_read_b64_tr_b16 v[88:89], v9 offset:25600
    ds_read_b64_tr_b16 v[90:91], v10 offset:25600
    s_add_u32 m0, s83, 94208
    s_nop 0
    buffer_load_dwordx4 v6, s[76:79], s86 offen lds
    s_waitcnt lgkmcnt(8)
    v_mfma_f32_16x16x32_bf16 v[64:67], v[104:107], v[112:115], v[64:67]
    v_mfma_f32_16x16x32_bf16 v[68:71], v[104:107], v[116:119], v[68:71]
    ds_read_b64_tr_b16 v[92:93], v9 offset:25608
    ds_read_b64_tr_b16 v[94:95], v10 offset:25608
    s_add_u32 s86, s86, 245760
    s_add_u32 s87, s87, 128
    s_cmp_eq_u32 s87, 1280
    s_cselect_b32 s86, 0, s86
    s_cselect_b32 s87, 0, s87
    s_waitcnt lgkmcnt(8)
    v_mfma_f32_16x16x32_bf16 v[72:75], v[108:111], v[112:115], v[72:75]
    v_mfma_f32_16x16x32_bf16 v[76:79], v[108:111], v[116:119], v[76:79]
    ds_read_b64_tr_b16 v[96:97], v9 offset:25616
    ds_read_b64_tr_b16 v[98:99], v10 offset:25616
    s_waitcnt lgkmcnt(8)
    v_mfma_f32_16x16x32_bf16 v[16:19], v[80:83], v[120:123], v[16:19]
    v_mfma_f32_16x16x32_bf16 v[20:23], v[80:83], v[124:127], v[20:23]
    ds_read_b64_tr_b16 v[100:101], v9 offset:25624
    ds_read_b64_tr_b16 v[102:103], v10 offset:25624
    s_waitcnt lgkmcnt(8)
    v_mfma_f32_16x16x32_bf16 v[24:27], v[84:87], v[120:123], v[24:27]
    v_mfma_f32_16x16x32_bf16 v[28:31], v[84:87], v[124:127], v[28:31]
    ds_read_b64_tr_b16 v[104:105], v9 offset:25632
    ds_read_b64_tr_b16 v[106:107], v10 offset:25632
    s_waitcnt lgkmcnt(8)
    v_mfma_f32_16x16x32_bf16 v[32:35], v[88:91], v[120:123], v[32:35]
    v_mfma_f32_16x16x32_bf16 v[36:39], v[88:91], v[124:127], v[36:39]
    ds_read_b64_tr_b16 v[108:109], v9 offset:25632
    ds_read_b64_tr_b16 v[110:111], v10 offset:25632
    s_waitcnt lgkmcnt(8)
    v_mfma_f32_16x16x32_bf16 v[40:43], v[92:95], v[120:123], v[40:43]
    v_mfma_f32_16x16x32_bf16 v[44:47], v[92:95], v[124:127], v[44:47]
    s_waitcnt vmcnt(6)
    s_barrier
    ds_read_b128 v[128:131], v164
    ds_read_b128 v[132:135], v164 offset:2048
    ds_read_b128 v[136:139], v167
    ds_read_b128 v[140:143], v167 offset:2048
    ds_read_b64_tr_b16 v[80:81], v160 offset:10264
    ds_read_b64_tr_b16 v[82:83], v161 offset:10264
    s_waitcnt lgkmcnt(12)
    v_mfma_f32_16x16x32_bf16 v[48:51], v[96:99], v[120:123], v[48:51]
    v_mfma_f32_16x16x32_bf16 v[52:55], v[96:99], v[124:127], v[52:55]
    ds_read_b64_tr_b16 v[84:85], v160 offset:10272
    ds_read_b64_tr_b16 v[86:87], v161 offset:10272
    s_waitcnt lgkmcnt(12)
    v_mfma_f32_16x16x32_bf16 v[56:59], v[100:103], v[120:123], v[56:59]
    v_mfma_f32_16x16x32_bf16 v[60:63], v[100:103], v[124:127], v[60:63]
    ds_read_b64_tr_b16 v[88:89], v160 offset:20480
    ds_read_b64_tr_b16 v[90:91], v161 offset:20480
    s_waitcnt lgkmcnt(12)
    v_mfma_f32_16x16x32_bf16 v[64:67], v[104:107], v[120:123], v[64:67]
    v_mfma_f32_16x16x32_bf16 v[68:71], v[104:107], v[124:127], v[68:71]
    ds_read_b64_tr_b16 v[92:93], v160 offset:20488
    ds_read_b64_tr_b16 v[94:95], v161 offset:20488
    s_waitcnt lgkmcnt(12)
    v_mfma_f32_16x16x32_bf16 v[72:75], v[108:111], v[120:123], v[72:75]
    v_mfma_f32_16x16x32_bf16 v[76:79], v[108:111], v[124:127], v[76:79]
    ds_read_b64_tr_b16 v[96:97], v160 offset:20496
    ds_read_b64_tr_b16 v[98:99], v161 offset:20496
    s_barrier
    s_waitcnt lgkmcnt(8)
    v_mfma_f32_16x16x32_bf16 v[16:19], v[80:83], v[128:131], v[16:19]
    v_mfma_f32_16x16x32_bf16 v[20:23], v[80:83], v[132:135], v[20:23]
    ds_read_b64_tr_b16 v[100:101], v160 offset:20504
    ds_read_b64_tr_b16 v[102:103], v161 offset:20504
    s_add_u32 m0, s84, 0
    s_nop 0
    buffer_load_dwordx4 v7, s[4:7], s87 offen lds
    s_waitcnt lgkmcnt(8)
    v_mfma_f32_16x16x32_bf16 v[24:27], v[84:87], v[128:131], v[24:27]
    v_mfma_f32_16x16x32_bf16 v[28:31], v[84:87], v[132:135], v[28:31]
    ds_read_b64_tr_b16 v[104:105], v160 offset:20512
    ds_read_b64_tr_b16 v[106:107], v161 offset:20512
    s_add_u32 m0, s85, 0
    s_nop 0
    buffer_load_dwordx4 v8, s[4:7], s87 offen lds
    s_waitcnt lgkmcnt(8)
    v_mfma_f32_16x16x32_bf16 v[32:35], v[88:91], v[128:131], v[32:35]
    v_mfma_f32_16x16x32_bf16 v[36:39], v[88:91], v[132:135], v[36:39]
    ds_read_b64_tr_b16 v[108:109], v160 offset:20512
    ds_read_b64_tr_b16 v[110:111], v161 offset:20512
    s_add_u32 m0, s80, 0
    s_nop 0
    buffer_load_dwordx4 v3, s[64:67], s86 offen lds
    s_waitcnt lgkmcnt(8)
    v_mfma_f32_16x16x32_bf16 v[40:43], v[92:95], v[128:131], v[40:43]
    v_mfma_f32_16x16x32_bf16 v[44:47], v[92:95], v[132:135], v[44:47]
    ds_read_b64_tr_b16 v[80:81], v160 offset:15384
    ds_read_b64_tr_b16 v[82:83], v161 offset:15384
    s_add_u32 m0, s81, 0
    s_nop 0
    buffer_load_dwordx4 v4, s[68:71], s86 offen lds
    s_waitcnt lgkmcnt(8)
    v_mfma_f32_16x16x32_bf16 v[48:51], v[96:99], v[128:131], v[48:51]
    v_mfma_f32_16x16x32_bf16 v[52:55], v[96:99], v[132:135], v[52:55]
    ds_read_b64_tr_b16 v[84:85], v160 offset:15392
    ds_read_b64_tr_b16 v[86:87], v161 offset:15392
    s_add_u32 m0, s82, 0
    s_nop 0
    buffer_load_dwordx4 v5, s[72:75], s86 offen lds
    s_waitcnt lgkmcnt(8)
    v_mfma_f32_16x16x32_bf16 v[56:59], v[100:103], v[128:131], v[56:59]
    v_mfma_f32_16x16x32_bf16 v[60:63], v[100:103], v[132:135], v[60:63]
    ds_read_b64_tr_b16 v[88:89], v160 offset:25600
    ds_read_b64_tr_b16 v[90:91], v161 offset:25600
    s_add_u32 m0, s83, 0
    s_nop 0
    buffer_load_dwordx4 v6, s[76:79], s86 offen lds
    s_waitcnt lgkmcnt(8)
    v_mfma_f32_16x16x32_bf16 v[64:67], v[104:107], v[128:131], v[64:67]
    v_mfma_f32_16x16x32_bf16 v[68:71], v[104:107], v[132:135], v[68:71]
    ds_read_b64_tr_b16 v[92:93], v160 offset:25608
    ds_read_b64_tr_b16 v[94:95], v161 offset:25608
    s_add_u32 s86, s86, 245760
    s_add_u32 s87, s87, 128
    s_cmp_eq_u32 s87, 1280
    s_cselect_b32 s86, 0, s86
    s_cselect_b32 s87, 0, s87
    s_waitcnt lgkmcnt(8)
    v_mfma_f32_16x16x32_bf16 v[72:75], v[108:111], v[128:131], v[72:75]
    v_mfma_f32_16x16x32_bf16 v[76:79], v[108:111], v[132:135], v[76:79]
    ds_read_b64_tr_b16 v[96:97], v160 offset:25616
    ds_read_b64_tr_b16 v[98:99], v161 offset:25616
    s_waitcnt lgkmcnt(8)
    v_mfma_f32_16x16x32_bf16 v[16:19], v[80:83], v[136:139], v[16:19]
    v_mfma_f32_16x16x32_bf16 v[20:23], v[80:83], v[140:143], v[20:23]
    ds_read_b64_tr_b16 v[100:101], v160 offset:25624
    ds_read_b64_tr_b16 v[102:103], v161 offset:25624
    s_waitcnt lgkmcnt(8)
    v_mfma_f32_16x16x32_bf16 v[24:27], v[84:87], v[136:139], v[24:27]
    v_mfma_f32_16x16x32_bf16 v[28:31], v[84:87], v[140:143], v[28:31]
    ds_read_b64_tr_b16 v[104:105], v160 offset:25632
    ds_read_b64_tr_b16 v[106:107], v161 offset:25632
    s_waitcnt lgkmcnt(8)
    v_mfma_f32_16x16x32_bf16 v[32:35], v[88:91], v[136:139], v[32:35]
    v_mfma_f32_16x16x32_bf16 v[36:39], v[88:91], v[140:143], v[36:39]
    ds_read_b64_tr_b16 v[108:109], v160 offset:25632
    ds_read_b64_tr_b16 v[110:111], v161 offset:25632
    s_waitcnt lgkmcnt(8)
    v_mfma_f32_16x16x32_bf16 v[40:43], v[92:95], v[136:139], v[40:43]
    v_mfma_f32_16x16x32_bf16 v[44:47], v[92:95], v[140:143], v[44:47]
    s_waitcnt vmcnt(6)
    s_barrier
    ds_read_b128 v[144:147], v165
    ds_read_b128 v[148:151], v165 offset:2048
    ds_read_b128 v[152:155], v168
    ds_read_b128 v[156:159], v168 offset:2048
    ds_read_b64_tr_b16 v[80:81], v162 offset:10264
    ds_read_b64_tr_b16 v[82:83], v163 offset:10264
    s_waitcnt lgkmcnt(12)
    v_mfma_f32_16x16x32_bf16 v[48:51], v[96:99], v[136:139], v[48:51]
    v_mfma_f32_16x16x32_bf16 v[52:55], v[96:99], v[140:143], v[52:55]
    ds_read_b64_tr_b16 v[84:85], v162 offset:10272
    ds_read_b64_tr_b16 v[86:87], v163 offset:10272
    s_waitcnt lgkmcnt(12)
    v_mfma_f32_16x16x32_bf16 v[56:59], v[100:103], v[136:139], v[56:59]
    v_mfma_f32_16x16x32_bf16 v[60:63], v[100:103], v[140:143], v[60:63]
    ds_read_b64_tr_b16 v[88:89], v162 offset:20480
    ds_read_b64_tr_b16 v[90:91], v163 offset:20480
    s_waitcnt lgkmcnt(12)
    v_mfma_f32_16x16x32_bf16 v[64:67], v[104:107], v[136:139], v[64:67]
    v_mfma_f32_16x16x32_bf16 v[68:71], v[104:107], v[140:143], v[68:71]
    ds_read_b64_tr_b16 v[92:93], v162 offset:20488
    ds_read_b64_tr_b16 v[94:95], v163 offset:20488
    s_waitcnt lgkmcnt(12)
    v_mfma_f32_16x16x32_bf16 v[72:75], v[108:111], v[136:139], v[72:75]
    v_mfma_f32_16x16x32_bf16 v[76:79], v[108:111], v[140:143], v[76:79]
    ds_read_b64_tr_b16 v[96:97], v162 offset:20496
    ds_read_b64_tr_b16 v[98:99], v163 offset:20496
    s_barrier
    s_cmp_eq_u32 s26, 1
    s_cselect_b32 s6, 0, s6
    s_cselect_b32 s66, 0, s66
    s_cselect_b32 s70, 0, s70
    s_cselect_b32 s74, 0, s74
    s_cselect_b32 s78, 0, s78
    s_waitcnt lgkmcnt(8)
    v_mfma_f32_16x16x32_bf16 v[16:19], v[80:83], v[144:147], v[16:19]
    v_mfma_f32_16x16x32_bf16 v[20:23], v[80:83], v[148:151], v[20:23]
    ds_read_b64_tr_b16 v[100:101], v162 offset:20504
    ds_read_b64_tr_b16 v[102:103], v163 offset:20504
    s_add_u32 m0, s84, 47104
    s_nop 0
    buffer_load_dwordx4 v7, s[4:7], s87 offen lds
    s_waitcnt lgkmcnt(8)
    v_mfma_f32_16x16x32_bf16 v[24:27], v[84:87], v[144:147], v[24:27]
    v_mfma_f32_16x16x32_bf16 v[28:31], v[84:87], v[148:151], v[28:31]
    ds_read_b64_tr_b16 v[104:105], v162 offset:20512
    ds_read_b64_tr_b16 v[106:107], v163 offset:20512
    s_add_u32 m0, s85, 47104
    s_nop 0
    buffer_load_dwordx4 v8, s[4:7], s87 offen lds
    s_waitcnt lgkmcnt(8)
    v_mfma_f32_16x16x32_bf16 v[32:35], v[88:91], v[144:147], v[32:35]
    v_mfma_f32_16x16x32_bf16 v[36:39], v[88:91], v[148:151], v[36:39]
    ds_read_b64_tr_b16 v[108:109], v162 offset:20512
    ds_read_b64_tr_b16 v[110:111], v163 offset:20512
    s_add_u32 m0, s80, 47104
    s_nop 0
    buffer_load_dwordx4 v3, s[64:67], s86 offen lds
    s_waitcnt lgkmcnt(8)
    v_mfma_f32_16x16x32_bf16 v[40:43], v[92:95], v[144:147], v[40:43]
    v_mfma_f32_16x16x32_bf16 v[44:47], v[92:95], v[148:151], v[44:47]
    ds_read_b64_tr_b16 v[80:81], v162 offset:15384
    ds_read_b64_tr_b16 v[82:83], v163 offset:15384
    s_add_u32 m0, s81, 47104
    s_nop 0
    buffer_load_dwordx4 v4, s[68:71], s86 offen lds
    s_waitcnt lgkmcnt(8)
    v_mfma_f32_16x16x32_bf16 v[48:51], v[96:99], v[144:147], v[48:51]
    v_mfma_f32_16x16x32_bf16 v[52:55], v[96:99], v[148:151], v[52:55]
    ds_read_b64_tr_b16 v[84:85], v162 offset:15392
    ds_read_b64_tr_b16 v[86:87], v163 offset:15392
    s_add_u32 m0, s82, 47104
    s_nop 0
    buffer_load_dwordx4 v5, s[72:75], s86 offen lds
    s_waitcnt lgkmcnt(8)
    v_mfma_f32_16x16x32_bf16 v[56:59], v[100:103], v[144:147], v[56:59]
    v_mfma_f32_16x16x32_bf16 v[60:63], v[100:103], v[148:151], v[60:63]
    ds_read_b64_tr_b16 v[88:89], v162 offset:25600
    ds_read_b64_tr_b16 v[90:91], v163 offset:25600
    s_add_u32 m0, s83, 47104
    s_nop 0
    buffer_load_dwordx4 v6, s[76:79], s86 offen lds
    s_waitcnt lgkmcnt(8)
    v_mfma_f32_16x16x32_bf16 v[64:67], v[104:107], v[144:147], v[64:67]
    v_mfma_f32_16x16x32_bf16 v[68:71], v[104:107], v[148:151], v[68:71]
    ds_read_b64_tr_b16 v[92:93], v162 offset:25608
    ds_read_b64_tr_b16 v[94:95], v163 offset:25608
    s_add_u32 s86, s86, 245760
    s_add_u32 s87, s87, 128
    s_cmp_eq_u32 s87, 1280
    s_cselect_b32 s86, 0, s86
    s_cselect_b32 s87, 0, s87
    s_waitcnt lgkmcnt(8)
    v_mfma_f32_16x16x32_bf16 v[72:75], v[108:111], v[144:147], v[72:75]
    v_mfma_f32_16x16x32_bf16 v[76:79], v[108:111], v[148:151], v[76:79]
    ds_read_b64_tr_b16 v[96:97], v162 offset:25616
    ds_read_b64_tr_b16 v[98:99], v163 offset:25616
    s_waitcnt lgkmcnt(8)
    v_mfma_f32_16x16x32_bf16 v[16:19], v[80:83], v[152:155], v[16:19]
    v_mfma_f32_16x16x32_bf16 v[20:23], v[80:83], v[156:159], v[20:23]
    ds_read_b64_tr_b16 v[100:101], v162 offset:25624
    ds_read_b64_tr_b16 v[102:103], v163 offset:25624
    s_waitcnt lgkmcnt(8)
    v_mfma_f32_16x16x32_bf16 v[24:27], v[84:87], v[152:155], v[24:27]
    v_mfma_f32_16x16x32_bf16 v[28:31], v[84:87], v[156:159], v[28:31]
    ds_read_b64_tr_b16 v[104:105], v162 offset:25632
    ds_read_b64_tr_b16 v[106:107], v163 offset:25632
    s_waitcnt lgkmcnt(8)
    v_mfma_f32_16x16x32_bf16 v[32:35], v[88:91], v[152:155], v[32:35]
    v_mfma_f32_16x16x32_bf16 v[36:39], v[88:91], v[156:159], v[36:39]
    ds_read_b64_tr_b16 v[108:109], v162 offset:25632
    ds_read_b64_tr_b16 v[110:111], v163 offset:25632
    s_waitcnt lgkmcnt(8)
    v_mfma_f32_16x16x32_bf16 v[40:43], v[92:95], v[152:155], v[40:43]
    v_mfma_f32_16x16x32_bf16 v[44:47], v[92:95], v[156:159], v[44:47]
    s_waitcnt vmcnt(6)
    s_barrier
    ds_read_b128 v[112:115], v15
    ds_read_b128 v[116:119], v15 offset:2048
    ds_read_b128 v[120:123], v166
    ds_read_b128 v[124:127], v166 offset:2048
    ds_read_b64_tr_b16 v[80:81], v9 offset:10264
    ds_read_b64_tr_b16 v[82:83], v10 offset:10264
    s_waitcnt lgkmcnt(12)
    v_mfma_f32_16x16x32_bf16 v[48:51], v[96:99], v[152:155], v[48:51]
    v_mfma_f32_16x16x32_bf16 v[52:55], v[96:99], v[156:159], v[52:55]
    ds_read_b64_tr_b16 v[84:85], v9 offset:10272
    ds_read_b64_tr_b16 v[86:87], v10 offset:10272
    s_waitcnt lgkmcnt(12)
    v_mfma_f32_16x16x32_bf16 v[56:59], v[100:103], v[152:155], v[56:59]
    v_mfma_f32_16x16x32_bf16 v[60:63], v[100:103], v[156:159], v[60:63]
    ds_read_b64_tr_b16 v[88:89], v9 offset:20480
    ds_read_b64_tr_b16 v[90:91], v10 offset:20480
    s_waitcnt lgkmcnt(12)
    v_mfma_f32_16x16x32_bf16 v[64:67], v[104:107], v[152:155], v[64:67]
    v_mfma_f32_16x16x32_bf16 v[68:71], v[104:107], v[156:159], v[68:71]
    ds_read_b64_tr_b16 v[92:93], v9 offset:20488
    ds_read_b64_tr_b16 v[94:95], v10 offset:20488
    s_waitcnt lgkmcnt(12)
    v_mfma_f32_16x16x32_bf16 v[72:75], v[108:111], v[152:155], v[72:75]
    v_mfma_f32_16x16x32_bf16 v[76:79], v[108:111], v[156:159], v[76:79]
    ds_read_b64_tr_b16 v[96:97], v9 offset:20496
    ds_read_b64_tr_b16 v[98:99], v10 offset:20496
    s_sub_u32 s26, s26, 1
    s_cmp_lg_u32 s26, 0
    s_cbranch_scc1 K1_LOOP1
    s_barrier
    s_waitcnt lgkmcnt(8)
    v_mfma_f32_16x16x32_bf16 v[16:19], v[80:83], v[112:115], v[16:19]
    v_mfma_f32_16x16x32_bf16 v[20:23], v[80:83], v[116:119], v[20:23]
    ds_read_b64_tr_b16 v[100:101], v9 offset:20504
    ds_read_b64_tr_b16 v[102:103], v10 offset:20504
    s_waitcnt lgkmcnt(8)
    v_mfma_f32_16x16x32_bf16 v[24:27], v[84:87], v[112:115], v[24:27]
    v_mfma_f32_16x16x32_bf16 v[28:31], v[84:87], v[116:119], v[28:31]
    ds_read_b64_tr_b16 v[104:105], v9 offset:20512
    ds_read_b64_tr_b16 v[106:107], v10 offset:20512
    s_waitcnt lgkmcnt(8)
    v_mfma_f32_16x16x32_bf16 v[32:35], v[88:91], v[112:115], v[32:35]
    v_mfma_f32_16x16x32_bf16 v[36:39], v[88:91], v[116:119], v[36:39]
    ds_read_b64_tr_b16 v[108:109], v9 offset:20512
    ds_read_b64_tr_b16 v[110:111], v10 offset:20512
    s_waitcnt lgkmcnt(8)
    v_mfma_f32_16x16x32_bf16 v[40:43], v[92:95], v[112:115], v[40:43]
    v_mfma_f32_16x16x32_bf16 v[44:47], v[92:95], v[116:119], v[44:47]
    ds_read_b64_tr_b16 v[80:81], v9 offset:15384
    ds_read_b64_tr_b16 v[82:83], v10 offset:15384
    s_waitcnt lgkmcnt(8)
    v_mfma_f32_16x16x32_bf16 v[48:51], v[96:99], v[112:115], v[48:51]
    v_mfma_f32_16x16x32_bf16 v[52:55], v[96:99], v[116:119], v[52:55]
    ds_read_b64_tr_b16 v[84:85], v9 offset:15392
    ds_read_b64_tr_b16 v[86:87], v10 offset:15392
    s_waitcnt lgkmcnt(8)
    v_mfma_f32_16x16x32_bf16 v[56:59], v[100:103], v[112:115], v[56:59]
    v_mfma_f32_16x16x32_bf16 v[60:63], v[100:103], v[116:119], v[60:63]
    ds_read_b64_tr_b16 v[88:89], v9 offset:25600
    ds_read_b64_tr_b16 v[90:91], v10 offset:25600
    s_waitcnt lgkmcnt(8)
    v_mfma_f32_16x16x32_bf16 v[64:67], v[104:107], v[112:115], v[64:67]
    v_mfma_f32_16x16x32_bf16 v[68:71], v[104:107], v[116:119], v[68:71]
    ds_read_b64_tr_b16 v[92:93], v9 offset:25608
    ds_read_b64_tr_b16 v[94:95], v10 offset:25608
    s_waitcnt lgkmcnt(8)
    v_mfma_f32_16x16x32_bf16 v[72:75], v[108:111], v[112:115], v[72:75]
    v_mfma_f32_16x16x32_bf16 v[76:79], v[108:111], v[116:119], v[76:79]
    ds_read_b64_tr_b16 v[96:97], v9 offset:25616
    ds_read_b64_tr_b16 v[98:99], v10 offset:25616
    s_waitcnt lgkmcnt(8)
    v_mfma_f32_16x16x32_bf16 v[16:19], v[80:83], v[120:123], v[16:19]
    v_mfma_f32_16x16x32_bf16 v[20:23], v[80:83], v[124:127], v[20:23]
    ds_read_b64_tr_b16 v[100:101], v9 offset:25624
    ds_read_b64_tr_b16 v[102:103], v10 offset:25624
    s_waitcnt lgkmcnt(8)
    v_mfma_f32_16x16x32_bf16 v[24:27], v[84:87], v[120:123], v[24:27]
    v_mfma_f32_16x16x32_bf16 v[28:31], v[84:87], v[124:127], v[28:31]
    ds_read_b64_tr_b16 v[104:105], v9 offset:25632
    ds_read_b64_tr_b16 v[106:107], v10 offset:25632
    s_waitcnt lgkmcnt(8)
    v_mfma_f32_16x16x32_bf16 v[32:35], v[88:91], v[120:123], v[32:35]
    v_mfma_f32_16x16x32_bf16 v[36:39], v[88:91], v[124:127], v[36:39]
    ds_read_b64_tr_b16 v[108:109], v9 offset:25632
    ds_read_b64_tr_b16 v[110:111], v10 offset:25632
    s_waitcnt lgkmcnt(8)
    v_mfma_f32_16x16x32_bf16 v[40:43], v[92:95], v[120:123], v[40:43]
    v_mfma_f32_16x16x32_bf16 v[44:47], v[92:95], v[124:127], v[44:47]
    s_waitcnt lgkmcnt(6)
    v_mfma_f32_16x16x32_bf16 v[48:51], v[96:99], v[120:123], v[48:51]
    v_mfma_f32_16x16x32_bf16 v[52:55], v[96:99], v[124:127], v[52:55]
    s_waitcnt lgkmcnt(4)
    v_mfma_f32_16x16x32_bf16 v[56:59], v[100:103], v[120:123], v[56:59]
    v_mfma_f32_16x16x32_bf16 v[60:63], v[100:103], v[124:127], v[60:63]
    s_waitcnt lgkmcnt(2)
    v_mfma_f32_16x16x32_bf16 v[64:67], v[104:107], v[120:123], v[64:67]
    v_mfma_f32_16x16x32_bf16 v[68:71], v[104:107], v[124:127], v[68:71]
    s_waitcnt lgkmcnt(0)
    v_mfma_f32_16x16x32_bf16 v[72:75], v[108:111], v[120:123], v[72:75]
    v_mfma_f32_16x16x32_bf16 v[76:79], v[108:111], v[124:127], v[76:79]
    s_waitcnt vmcnt(0)
    s_cmp_eq_u32 s20, 0
    s_cbranch_scc0 K1_E11
    s_barrier
    s_lshl_b32 s43, s23, 6
    v_add_u32 v11, s43, v0
    v_lshlrev_b32 v12, 4, v11
    v_add_u32 v12, 141312, v12
    v_cmp_gt_u32 vcc, 256, v11
    s_nop 1
    s_and_saveexec_b64 s[52:53], vcc
    ds_write_b128 v12, v[244:247]
    s_mov_b64 exec, s[52:53]
    s_lshl_b32 s42, s22, 2
    v_add_u32 v14, s42, v2
    v_add_u32 v11, s46, v1
    v_mul_u32_u24 v12, 6144, v14
    v_add_lshl_u32 v5, v12, v11, 4
    v_lshl_add_u32 v12, v14, 11, v11
    v_lshlrev_b32 v6, 2, v12
    s_mul_i32 s42, s23, 3072
    s_xor_b32 s43, s23, 4
    s_mul_i32 s43, s43, 3072
    v_lshlrev_b32 v11, 4, v0
    v_add_u32 v11, 65536, v11
    v_add_u32 v12, s42, v11
    v_add_u32 v13, s43, v11
    ds_write_b128 v12, v[16:19] offset:0
    ds_write_b128 v12, v[24:27] offset:1024
    v_mov_b32 v132, v20
    v_mov_b32 v133, v21
    v_mov_b32 v134, v22
    v_mov_b32 v135, v23
    v_mov_b32 v136, v28
    v_mov_b32 v137, v29
    v_mov_b32 v138, v30
    v_mov_b32 v139, v31
    s_waitcnt lgkmcnt(0)
    s_barrier
    ds_read_b128 v[120:123], v13 offset:0
    ds_read_b128 v[124:127], v13 offset:1024
    ds_read_b128 v[128:131], v13 offset:2048
    v_lshrrev_b32 v11, 2, v1
    v_and_b32 v12, 3, v1
    v_mul_u32_u24 v13, 800, v2
    v_mul_u32_u24 v11, 40, v11
    v_add_u32 v13, v13, v11
    v_mov_b32 v11, 3200
    v_cmp_eq_u32 vcc, v12, v2
    s_nop 1
    v_cndmask_b32 v13, v11, v13, vcc
    v_add_u32 v13, 141312, v13
    ds_read_b64_tr_b16 v[144:145], v13 offset:0
    ds_read_b64_tr_b16 v[146:147], v13 offset:160
    ds_read_b64_tr_b16 v[148:149], v13 offset:320
    ds_read_b64_tr_b16 v[150:151], v13 offset:480
    ds_read_b64_tr_b16 v[152:153], v13 offset:640
    ds_read_b64_tr_b16 v[154:155], v13 offset:8
    ds_read_b64_tr_b16 v[156:157], v13 offset:168
    ds_read_b64_tr_b16 v[158:159], v13 offset:328
    s_waitcnt lgkmcnt(0)
    ds_read_b64_tr_b16 v[160:161], v13 offset:488
    ds_read_b64_tr_b16 v[162:163], v13 offset:648
    ds_read_b64_tr_b16 v[164:165], v13 offset:16
    ds_read_b64_tr_b16 v[166:167], v13 offset:176
    ds_read_b64_tr_b16 v[168:169], v13 offset:336
    ds_read_b64_tr_b16 v[170:171], v13 offset:496
    ds_read_b64_tr_b16 v[172:173], v13 offset:656
    ds_read_b64_tr_b16 v[174:175], v13 offset:24
    s_waitcnt lgkmcnt(0)
    ds_read_b64_tr_b16 v[176:177], v13 offset:184
    ds_read_b64_tr_b16 v[178:179], v13 offset:344
    ds_read_b64_tr_b16 v[180:181], v13 offset:504
    ds_read_b64_tr_b16 v[182:183], v13 offset:664
    ds_read_b64_tr_b16 v[184:185], v13 offset:32
    ds_read_b64_tr_b16 v[186:187], v13 offset:192
    ds_read_b64_tr_b16 v[188:189], v13 offset:352
    ds_read_b64_tr_b16 v[190:191], v13 offset:512
    s_waitcnt lgkmcnt(0)
    ds_read_b64_tr_b16 v[192:193], v13 offset:672
    s_waitcnt lgkmcnt(0)
    s_lshl_b32 s44, s24, 5
    v_add_u32 v11, s44, v1
    v_lshl_add_u32 v11, v2, 7, v11
    v_mul_u32_u24 v7, 48, v11
    v_add_u32 v11, 16, v11
    v_mul_u32_u24 v13, 80, v11
    v_mov_b32 v3, v13
    v_cvt_pk_bf16_f32 v80, v32, v33
    v_cvt_pk_bf16_f32 v81, v34, v35
    v_cvt_pk_bf16_f32 v82, v40, v41
    v_cvt_pk_bf16_f32 v83, v42, v43
    v_cvt_pk_bf16_f32 v84, v48, v49
    v_cvt_pk_bf16_f32 v85, v50, v51
    v_cvt_pk_bf16_f32 v86, v56, v57
    v_cvt_pk_bf16_f32 v87, v58, v59
    v_cvt_pk_bf16_f32 v88, v64, v65
    v_cvt_pk_bf16_f32 v89, v66, v67
    v_mov_b32 v90, 0x3f80
    v_mov_b32 v91, 0
    ds_write_b128 v7, v[80:83] offset:40960
    ds_write_b128 v7, v[84:87] offset:40976
    ds_write_b128 v7, v[88:91] offset:40992
    v_cvt_pk_bf16_f32 v100, v36, v37
    v_cvt_pk_bf16_f32 v101, v38, v39
    v_cvt_pk_bf16_f32 v102, v44, v45
    v_cvt_pk_bf16_f32 v103, v46, v47
    v_cvt_pk_bf16_f32 v104, v52, v53
    v_cvt_pk_bf16_f32 v105, v54, v55
    v_cvt_pk_bf16_f32 v106, v60, v61
    v_cvt_pk_bf16_f32 v107, v62, v63
    v_cvt_pk_bf16_f32 v108, v68, v69
    v_cvt_pk_bf16_f32 v109, v70, v71
    v_mov_b32 v110, 0x3f80
    v_mov_b32 v111, 0
    ds_write_b128 v7, v[100:103] offset:41728
    ds_write_b128 v7, v[104:107] offset:41744
    ds_write_b128 v7, v[108:111] offset:41760
    v_cvt_pk_bf16_f32 v194, v120, v121
    v_cvt_pk_bf16_f32 v195, v122, v123
    v_cvt_pk_bf16_f32 v196, v124, v125
    v_cvt_pk_bf16_f32 v197, v126, v127
    v_cvt_pk_bf16_f32 v198, v128, v129
    v_cvt_pk_bf16_f32 v199, v130, v131
    v_cvt_pk_bf16_f32 v200, v132, v133
    v_cvt_pk_bf16_f32 v201, v134, v135
    v_cvt_pk_bf16_f32 v202, v136, v137
    v_cvt_pk_bf16_f32 v203, v138, v139
    s_waitcnt lgkmcnt(0)
    v_mfma_f32_16x16x32_bf16 v[204:207], v[144:147], v[194:197], 0
    v_mfma_f32_16x16x32_bf16 v[208:211], v[154:157], v[194:197], 0
    v_mfma_f32_16x16x32_bf16 v[212:215], v[164:167], v[194:197], 0
    v_mfma_f32_16x16x32_bf16 v[216:219], v[174:177], v[194:197], 0
    v_mfma_f32_16x16x32_bf16 v[220:223], v[184:187], v[194:197], 0
    v_mfma_f32_16x16x32_bf16 v[204:207], v[148:151], v[198:201], v[204:207]
    v_mfma_f32_16x16x32_bf16 v[208:211], v[158:161], v[198:201], v[208:211]
    v_mfma_f32_16x16x32_bf16 v[212:215], v[168:171], v[198:201], v[212:215]
    v_mfma_f32_16x16x32_bf16 v[216:219], v[178:181], v[198:201], v[216:219]
    v_mfma_f32_16x16x32_bf16 v[220:223], v[188:191], v[198:201], v[220:223]
    v_mfma_f32_16x16x16_bf16 v[204:207], v[152:153], v[202:203], v[204:207]
    v_mfma_f32_16x16x16_bf16 v[208:211], v[162:163], v[202:203], v[208:211]
    v_mfma_f32_16x16x16_bf16 v[212:215], v[172:173], v[202:203], v[212:215]
    v_mfma_f32_16x16x16_bf16 v[216:219], v[182:183], v[202:203], v[216:219]
    v_mfma_f32_16x16x16_bf16 v[220:223], v[192:193], v[202:203], v[220:223]
    s_mov_b32 s45, 1069066811
    s_nop 2
    v_max3_f32 v8, v204, v205, v206
    v_min3_f32 v9, v204, v205, v206
    v_max3_f32 v8, v8, v207, v208
    v_min3_f32 v9, v9, v207, v208
    v_max3_f32 v8, v8, v209, v210
    v_min3_f32 v9, v9, v209, v210
    v_max3_f32 v8, v8, v211, v212
    v_min3_f32 v9, v9, v211, v212
    v_max3_f32 v8, v8, v213, v214
    v_min3_f32 v9, v9, v213, v214
    v_max3_f32 v8, v8, v215, v216
    v_min3_f32 v9, v9, v215, v216
    v_max3_f32 v8, v8, v217, v218
    v_min3_f32 v9, v9, v217, v218
    v_max3_f32 v8, v8, v219, v220
    v_min3_f32 v9, v9, v219, v220
    v_max3_f32 v8, v8, v221, v222
    v_min3_f32 v9, v9, v221, v222
    v_max_f32 v8, v8, v223
    v_min_f32 v9, v9, v223
    v_mul_f32 v8, s45, v8
    v_mul_f32 v9, s45, v9
    v_fma_f32 v224, -v204, s45, v9
    v_fma_f32 v204, v204, s45, -v8
    v_fma_f32 v225, -v205, s45, v9
    v_fma_f32 v205, v205, s45, -v8
    v_fma_f32 v226, -v206, s45, v9
    v_fma_f32 v206, v206, s45, -v8
    v_fma_f32 v227, -v207, s45, v9
    v_fma_f32 v207, v207, s45, -v8
    v_fma_f32 v228, -v208, s45, v9
    v_fma_f32 v208, v208, s45, -v8
    v_fma_f32 v229, -v209, s45, v9
    v_fma_f32 v209, v209, s45, -v8
    v_fma_f32 v230, -v210, s45, v9
    v_fma_f32 v210, v210, s45, -v8
    v_fma_f32 v231, -v211, s45, v9
    v_fma_f32 v211, v211, s45, -v8
    v_fma_f32 v232, -v212, s45, v9
    v_fma_f32 v212, v212, s45, -v8
    v_fma_f32 v233, -v213, s45, v9
    v_fma_f32 v213, v213, s45, -v8
    v_fma_f32 v234, -v214, s45, v9
    v_fma_f32 v214, v214, s45, -v8
    v_fma_f32 v235, -v215, s45, v9
    v_fma_f32 v215, v215, s45, -v8
    v_fma_f32 v236, -v216, s45, v9
    v_fma_f32 v216, v216, s45, -v8
    v_fma_f32 v237, -v217, s45, v9
    v_fma_f32 v217, v217, s45, -v8
    v_fma_f32 v238, -v218, s45, v9
    v_fma_f32 v218, v218, s45, -v8
    v_fma_f32 v239, -v219, s45, v9
    v_fma_f32 v219, v219, s45, -v8
    v_fma_f32 v240, -v220, s45, v9
    v_fma_f32 v220, v220, s45, -v8
    v_fma_f32 v241, -v221, s45, v9
    v_fma_f32 v221, v221, s45, -v8
    v_fma_f32 v242, -v222, s45, v9
    v_fma_f32 v222, v222, s45, -v8
    v_fma_f32 v243, -v223, s45, v9
    v_fma_f32 v223, v223, s45, -v8
    v_exp_f32 v204, v204
    v_exp_f32 v224, v224
    v_exp_f32 v205, v205
    v_exp_f32 v225, v225
    v_exp_f32 v206, v206
    v_exp_f32 v226, v226
    v_exp_f32 v207, v207
    v_exp_f32 v227, v227
    v_exp_f32 v208, v208
    v_exp_f32 v228, v228
    v_exp_f32 v209, v209
    v_exp_f32 v229, v229
    v_exp_f32 v210, v210
    v_exp_f32 v230, v230
    v_exp_f32 v211, v211
    v_exp_f32 v231, v231
    v_exp_f32 v212, v212
    v_exp_f32 v232, v232
    v_exp_f32 v213, v213
    v_exp_f32 v233, v233
    v_exp_f32 v214, v214
    v_exp_f32 v234, v234
    v_exp_f32 v215, v215
    v_exp_f32 v235, v235
    v_exp_f32 v216, v216
    v_exp_f32 v236, v236
    v_exp_f32 v217, v217
    v_exp_f32 v237, v237
    v_exp_f32 v218, v218
    v_exp_f32 v238, v238
    v_exp_f32 v219, v219
    v_exp_f32 v239, v239
    v_exp_f32 v220, v220
    v_exp_f32 v240, v240
    v_exp_f32 v221, v221
    v_exp_f32 v241, v241
    v_exp_f32 v222, v222
    v_exp_f32 v242, v242
    v_exp_f32 v223, v223
    v_exp_f32 v243, v243
    v_add_f32 v8, v204, v205
    v_add_f32 v9, v224, v225
    v_add_f32 v8, v8, v206
    v_add_f32 v9, v9, v226
    v_add_f32 v8, v8, v207
    v_add_f32 v9, v9, v227
    v_add_f32 v8, v8, v208
    v_add_f32 v9, v9, v228
    v_add_f32 v8, v8, v209
    v_add_f32 v9, v9, v229
    v_add_f32 v8, v8, v210
    v_add_f32 v9, v9, v230
    v_add_f32 v8, v8, v211
    v_add_f32 v9, v9, v231
    v_add_f32 v8, v8, v212
    v_add_f32 v9, v9, v232
    v_add_f32 v8, v8, v213
    v_add_f32 v9, v9, v233
    v_add_f32 v8, v8, v214
    v_add_f32 v9, v9, v234
    v_add_f32 v8, v8, v215
    v_add_f32 v9, v9, v235
    v_add_f32 v8, v8, v216
    v_add_f32 v9, v9, v236
    v_add_f32 v8, v8, v217
    v_add_f32 v9, v9, v237
    v_add_f32 v8, v8, v218
    v_add_f32 v9, v9, v238
    v_add_f32 v8, v8, v219
    v_add_f32 v9, v9, v239
    v_add_f32 v8, v8, v220
    v_add_f32 v9, v9, v240
    v_add_f32 v8, v8, v221
    v_add_f32 v9, v9, v241
    v_add_f32 v8, v8, v222
    v_add_f32 v9, v9, v242
    v_add_f32 v8, v8, v223
    v_add_f32 v9, v9, v243
    v_rcp_f32 v8, v8
    v_rcp_f32 v9, v9
    v_mul_f32 v204, v8, v204
    v_mul_f32 v224, v9, v224
    v_mul_f32 v205, v8, v205
    v_mul_f32 v225, v9, v225
    v_mul_f32 v206, v8, v206
    v_mul_f32 v226, v9, v226
    v_mul_f32 v207, v8, v207
    v_mul_f32 v227, v9, v227
    v_mul_f32 v208, v8, v208
    v_mul_f32 v228, v9, v228
    v_mul_f32 v209, v8, v209
    v_mul_f32 v229, v9, v229
    v_mul_f32 v210, v8, v210
    v_mul_f32 v230, v9, v230
    v_mul_f32 v211, v8, v211
    v_mul_f32 v231, v9, v231
    v_mul_f32 v212, v8, v212
    v_mul_f32 v232, v9, v232
    v_mul_f32 v213, v8, v213
    v_mul_f32 v233, v9, v233
    v_mul_f32 v214, v8, v214
    v_mul_f32 v234, v9, v234
    v_mul_f32 v215, v8, v215
    v_mul_f32 v235, v9, v235
    v_mul_f32 v216, v8, v216
    v_mul_f32 v236, v9, v236
    v_mul_f32 v217, v8, v217
    v_mul_f32 v237, v9, v237
    v_mul_f32 v218, v8, v218
    v_mul_f32 v238, v9, v238
    v_mul_f32 v219, v8, v219
    v_mul_f32 v239, v9, v239
    v_mul_f32 v220, v8, v220
    v_mul_f32 v240, v9, v240
    v_mul_f32 v221, v8, v221
    v_mul_f32 v241, v9, v241
    v_mul_f32 v222, v8, v222
    v_mul_f32 v242, v9, v242
    v_mul_f32 v223, v8, v223
    v_mul_f32 v243, v9, v243
    v_cvt_pk_bf16_f32 v80, v204, v205
    v_cvt_pk_bf16_f32 v90, v224, v225
    v_cvt_pk_bf16_f32 v81, v206, v207
    v_cvt_pk_bf16_f32 v91, v226, v227
    v_cvt_pk_bf16_f32 v82, v208, v209
    v_cvt_pk_bf16_f32 v92, v228, v229
    v_cvt_pk_bf16_f32 v83, v210, v211
    v_cvt_pk_bf16_f32 v93, v230, v231
    v_cvt_pk_bf16_f32 v84, v212, v213
    v_cvt_pk_bf16_f32 v94, v232, v233
    v_cvt_pk_bf16_f32 v85, v214, v215
    v_cvt_pk_bf16_f32 v95, v234, v235
    v_cvt_pk_bf16_f32 v86, v216, v217
    v_cvt_pk_bf16_f32 v96, v236, v237
    v_cvt_pk_bf16_f32 v87, v218, v219
    v_cvt_pk_bf16_f32 v97, v238, v239
    v_cvt_pk_bf16_f32 v88, v220, v221
    v_cvt_pk_bf16_f32 v98, v240, v241
    v_cvt_pk_bf16_f32 v89, v222, v223
    v_cvt_pk_bf16_f32 v99, v242, v243
    ds_write_b128 v3, v[80:83] offset:0
    ds_write_b128 v3, v[84:87] offset:16
    ds_write_b128 v3, v[88:91] offset:32
    ds_write_b128 v3, v[92:95] offset:48
    ds_write_b128 v3, v[96:99] offset:64
    s_waitcnt lgkmcnt(0)
    s_barrier
    v_lshrrev_b32 v11, 2, v1
    v_and_b32 v12, 3, v1
    v_lshl_add_u32 v11, v2, 3, v11
    s_lshl_b32 s44, s24, 7
    v_add_u32 v11, s44, v11
    v_mul_u32_u24 v13, 80, v11
    v_lshl_add_u32 v13, v12, 3, v13
    v_mul_u32_u24 v15, 48, v11
    v_lshl_add_u32 v15, v12, 3, v15
    s_lshl_b32 s44, s25, 5
    v_add_u32 v15, s44, v15
    ds_read_b64_tr_b16 v[32:33], v13 offset:0
    ds_read_b64_tr_b16 v[34:35], v13 offset:320
    ds_read_b64_tr_b16 v[36:37], v13 offset:32
    ds_read_b64_tr_b16 v[38:39], v13 offset:352
    ds_read_b64_tr_b16 v[40:41], v13 offset:64
    ds_read_b64_tr_b16 v[42:43], v13 offset:384
    ds_read_b64_tr_b16 v[44:45], v15 offset:40960
    ds_read_b64_tr_b16 v[46:47], v15 offset:41152
    s_waitcnt lgkmcnt(1)
    ds_read_b64_tr_b16 v[48:49], v13 offset:2560
    ds_read_b64_tr_b16 v[50:51], v13 offset:2880
    ds_read_b64_tr_b16 v[52:53], v13 offset:2592
    ds_read_b64_tr_b16 v[54:55], v13 offset:2912
    ds_read_b64_tr_b16 v[56:57], v13 offset:2624
    ds_read_b64_tr_b16 v[58:59], v13 offset:2944
    ds_read_b64_tr_b16 v[60:61], v15 offset:42496
    ds_read_b64_tr_b16 v[62:63], v15 offset:42688
    s_waitcnt lgkmcnt(8)
    v_mfma_f32_16x16x32_bf16 v[16:19], v[32:35], v[44:47], 0
    v_mfma_f32_16x16x32_bf16 v[20:23], v[36:39], v[44:47], 0
    v_mfma_f32_16x16x32_bf16 v[24:27], v[40:43], v[44:47], 0
    s_waitcnt lgkmcnt(1)
    ds_read_b64_tr_b16 v[64:65], v13 offset:5120
    ds_read_b64_tr_b16 v[66:67], v13 offset:5440
    ds_read_b64_tr_b16 v[68:69], v13 offset:5152
    ds_read_b64_tr_b16 v[70:71], v13 offset:5472
    ds_read_b64_tr_b16 v[72:73], v13 offset:5184
    ds_read_b64_tr_b16 v[74:75], v13 offset:5504
    ds_read_b64_tr_b16 v[76:77], v15 offset:44032
    ds_read_b64_tr_b16 v[78:79], v15 offset:44224
    s_waitcnt lgkmcnt(8)
    v_mfma_f32_16x16x32_bf16 v[16:19], v[48:51], v[60:63], v[16:19]
    v_mfma_f32_16x16x32_bf16 v[20:23], v[52:55], v[60:63], v[20:23]
    v_mfma_f32_16x16x32_bf16 v[24:27], v[56:59], v[60:63], v[24:27]
    s_waitcnt lgkmcnt(1)
    ds_read_b64_tr_b16 v[80:81], v13 offset:7680
    ds_read_b64_tr_b16 v[82:83], v13 offset:8000
    ds_read_b64_tr_b16 v[84:85], v13 offset:7712
    ds_read_b64_tr_b16 v[86:87], v13 offset:8032
    ds_read_b64_tr_b16 v[88:89], v13 offset:7744
    ds_read_b64_tr_b16 v[90:91], v13 offset:8064
    ds_read_b64_tr_b16 v[92:93], v15 offset:45568
    ds_read_b64_tr_b16 v[94:95], v15 offset:45760
    s_waitcnt lgkmcnt(8)
    v_mfma_f32_16x16x32_bf16 v[16:19], v[64:67], v[76:79], v[16:19]
    v_mfma_f32_16x16x32_bf16 v[20:23], v[68:71], v[76:79], v[20:23]
    v_mfma_f32_16x16x32_bf16 v[24:27], v[72:75], v[76:79], v[24:27]
    s_waitcnt lgkmcnt(0)
    v_mfma_f32_16x16x32_bf16 v[16:19], v[80:83], v[92:95], v[16:19]
    v_mfma_f32_16x16x32_bf16 v[20:23], v[84:87], v[92:95], v[20:23]
    v_mfma_f32_16x16x32_bf16 v[24:27], v[88:91], v[92:95], v[24:27]
    s_lshl_b32 s42, s22, 2
    s_add_u32 s42, s42, s24
    s_lshl_b32 s42, s42, 4
    s_add_u32 s42, s42, s21
    s_mul_i32 s42, s42, 3360
    s_add_u32 s42, s42, 14966784
    s_lshl_b32 s44, s25, 4
    v_add_u32 v12, s44, v1
    v_mul_u32_u24 v11, 160, v12
    v_lshl_add_u32 v11, v2, 4, v11
    v_cmp_gt_u32 s[52:53], 21, v12
    v_cmp_gt_u32 s[54:55], 2, v2
    s_nop 1
    s_and_b64 s[54:55], s[52:53], s[54:55]
    s_mov_b64 exec, s[52:53]
    buffer_store_dwordx4 v[16:19], v11, s[56:59], s42 offen offset:0
    s_mov_b64 exec, s[52:53]
    buffer_store_dwordx4 v[20:23], v11, s[56:59], s42 offen offset:64
    s_mov_b64 exec, s[54:55]
    buffer_store_dwordx4 v[24:27], v11, s[56:59], s42 offen offset:128
    s_mov_b64 exec, -1
    s_branch K1_FIN
K1_E11:
    s_barrier
    s_mov_b32 s8, s38
    s_and_b32 s9, s39, 0xffff
    s_mov_b32 s10, 1280
    s_mov_b32 s11, 0x00020000
    s_mov_b32 s6, 2621440
    s_lshl_b32 s42, s21, 7
    s_lshl_b32 s43, s22, 4
    s_add_u32 s42, s42, s43
    s_lshl_b32 s43, s24, 2
    s_add_u32 s47, s42, s43
    v_add_u32 v11, s47, v2
    v_mul_u32_u24 v12, 80, v1
    v_mul_u32_u24 v13, 1280, v11
    v_add_u32 v13, v13, v12
    buffer_load_dwordx4 v[204:207], v13, s[4:7], 0 offen offset:0
    buffer_load_dwordx4 v[224:227], v12, s[8:11], 0 offen offset:0
    buffer_load_dwordx4 v[208:211], v13, s[4:7], 0 offen offset:16
    buffer_load_dwordx4 v[228:231], v12, s[8:11], 0 offen offset:16
    buffer_load_dwordx4 v[212:215], v13, s[4:7], 0 offen offset:32
    buffer_load_dwordx4 v[232:235], v12, s[8:11], 0 offen offset:32
    buffer_load_dwordx4 v[216:219], v13, s[4:7], 0 offen offset:48
    buffer_load_dwordx4 v[236:239], v12, s[8:11], 0 offen offset:48
    buffer_load_dwordx4 v[220:223], v13, s[4:7], 0 offen offset:64
    buffer_load_dwordx4 v[240:243], v12, s[8:11], 0 offen offset:64
    s_lshl_b32 s43, s23, 6
    v_add_u32 v11, s43, v0
    v_lshlrev_b32 v12, 4, v11
    v_add_u32 v12, 141312, v12
    v_cmp_gt_u32 vcc, 256, v11
    s_nop 1
    s_and_saveexec_b64 s[52:53], vcc
    ds_write_b128 v12, v[244:247]
    s_mov_b64 exec, s[52:53]
    s_lshl_b32 s42, s22, 2
    v_add_u32 v14, s42, v2
    v_add_u32 v11, s46, v1
    v_mul_u32_u24 v12, 6144, v14
    v_add_lshl_u32 v5, v12, v11, 4
    v_lshl_add_u32 v12, v14, 11, v11
    v_lshlrev_b32 v6, 2, v12
    s_mul_i32 s42, s23, 3072
    s_xor_b32 s43, s23, 4
    s_mul_i32 s43, s43, 3072
    v_lshlrev_b32 v11, 4, v0
    v_add_u32 v11, 65536, v11
    v_add_u32 v12, s42, v11
    v_add_u32 v13, s43, v11
    ds_write_b128 v12, v[16:19] offset:0
    ds_write_b128 v12, v[24:27] offset:1024
    v_mov_b32 v132, v20
    v_mov_b32 v133, v21
    v_mov_b32 v134, v22
    v_mov_b32 v135, v23
    v_mov_b32 v136, v28
    v_mov_b32 v137, v29
    v_mov_b32 v138, v30
    v_mov_b32 v139, v31
    s_waitcnt lgkmcnt(0)
    s_barrier
    ds_read_b128 v[120:123], v13 offset:0
    ds_read_b128 v[124:127], v13 offset:1024
    ds_read_b128 v[128:131], v13 offset:2048
    v_lshrrev_b32 v11, 2, v1
    v_and_b32 v12, 3, v1
    v_mul_u32_u24 v13, 800, v2
    v_mul_u32_u24 v11, 40, v11
    v_add_u32 v13, v13, v11
    v_mov_b32 v11, 3200
    v_cmp_eq_u32 vcc, v12, v2
    s_nop 1
    v_cndmask_b32 v13, v11, v13, vcc
    v_add_u32 v13, 141312, v13
    ds_read_b64_tr_b16 v[144:145], v13 offset:0
    ds_read_b64_tr_b16 v[146:147], v13 offset:160
    ds_read_b64_tr_b16 v[148:149], v13 offset:320
    ds_read_b64_tr_b16 v[150:151], v13 offset:480
    ds_read_b64_tr_b16 v[152:153], v13 offset:640
    ds_read_b64_tr_b16 v[154:155], v13 offset:8
    ds_read_b64_tr_b16 v[156:157], v13 offset:168
    ds_read_b64_tr_b16 v[158:159], v13 offset:328
    s_waitcnt lgkmcnt(0)
    ds_read_b64_tr_b16 v[160:161], v13 offset:488
    ds_read_b64_tr_b16 v[162:163], v13 offset:648
    ds_read_b64_tr_b16 v[164:165], v13 offset:16
    ds_read_b64_tr_b16 v[166:167], v13 offset:176
    ds_read_b64_tr_b16 v[168:169], v13 offset:336
    ds_read_b64_tr_b16 v[170:171], v13 offset:496
    ds_read_b64_tr_b16 v[172:173], v13 offset:656
    ds_read_b64_tr_b16 v[174:175], v13 offset:24
    s_waitcnt lgkmcnt(0)
    ds_read_b64_tr_b16 v[176:177], v13 offset:184
    ds_read_b64_tr_b16 v[178:179], v13 offset:344
    ds_read_b64_tr_b16 v[180:181], v13 offset:504
    ds_read_b64_tr_b16 v[182:183], v13 offset:664
    ds_read_b64_tr_b16 v[184:185], v13 offset:32
    ds_read_b64_tr_b16 v[186:187], v13 offset:192
    ds_read_b64_tr_b16 v[188:189], v13 offset:352
    ds_read_b64_tr_b16 v[190:191], v13 offset:512
    s_waitcnt lgkmcnt(0)
    ds_read_b64_tr_b16 v[192:193], v13 offset:672
    s_waitcnt lgkmcnt(0)
    v_cvt_pk_bf16_f32 v80, v32, v33
    v_cvt_pk_bf16_f32 v81, v34, v35
    v_cvt_pk_bf16_f32 v82, v40, v41
    v_cvt_pk_bf16_f32 v83, v42, v43
    v_cvt_pk_bf16_f32 v84, v48, v49
    v_cvt_pk_bf16_f32 v85, v50, v51
    v_cvt_pk_bf16_f32 v86, v56, v57
    v_cvt_pk_bf16_f32 v87, v58, v59
    v_cvt_pk_bf16_f32 v88, v64, v65
    v_cvt_pk_bf16_f32 v89, v66, v67
    v_mov_b32 v90, 0x3f80
    v_mov_b32 v91, 0
    s_mov_b32 s43, 6291456
    buffer_store_dwordx4 v[80:83], v5, s[56:59], s43 offen offset:0
    s_add_u32 s43, s43, 32768
    buffer_store_dwordx4 v[84:87], v5, s[56:59], s43 offen offset:0
    s_add_u32 s43, s43, 32768
    buffer_store_dwordx4 v[88:91], v5, s[56:59], s43 offen offset:0
    v_cvt_pk_bf16_f32 v100, v36, v37
    v_cvt_pk_bf16_f32 v101, v38, v39
    v_cvt_pk_bf16_f32 v102, v44, v45
    v_cvt_pk_bf16_f32 v103, v46, v47
    v_cvt_pk_bf16_f32 v104, v52, v53
    v_cvt_pk_bf16_f32 v105, v54, v55
    v_cvt_pk_bf16_f32 v106, v60, v61
    v_cvt_pk_bf16_f32 v107, v62, v63
    v_cvt_pk_bf16_f32 v108, v68, v69
    v_cvt_pk_bf16_f32 v109, v70, v71
    v_mov_b32 v110, 0x3f80
    v_mov_b32 v111, 0
    s_mov_b32 s43, 6291456
    buffer_store_dwordx4 v[100:103], v5, s[56:59], s43 offen offset:256
    s_add_u32 s43, s43, 32768
    buffer_store_dwordx4 v[104:107], v5, s[56:59], s43 offen offset:256
    s_add_u32 s43, s43, 32768
    buffer_store_dwordx4 v[108:111], v5, s[56:59], s43 offen offset:256
    s_waitcnt vmcnt(6)
    v_mov_b32 v8, 0
    v_dot2_f32_bf16 v8, v204, v224, v8
    v_dot2_f32_bf16 v8, v205, v225, v8
    v_dot2_f32_bf16 v8, v206, v226, v8
    v_dot2_f32_bf16 v8, v207, v227, v8
    v_dot2_f32_bf16 v8, v208, v228, v8
    v_dot2_f32_bf16 v8, v209, v229, v8
    v_dot2_f32_bf16 v8, v210, v230, v8
    v_dot2_f32_bf16 v8, v211, v231, v8
    v_dot2_f32_bf16 v8, v212, v232, v8
    v_dot2_f32_bf16 v8, v213, v233, v8
    v_dot2_f32_bf16 v8, v214, v234, v8
    v_dot2_f32_bf16 v8, v215, v235, v8
    v_dot2_f32_bf16 v8, v216, v236, v8
    v_dot2_f32_bf16 v8, v217, v237, v8
    v_dot2_f32_bf16 v8, v218, v238, v8
    v_dot2_f32_bf16 v8, v219, v239, v8
    v_dot2_f32_bf16 v8, v220, v240, v8
    v_dot2_f32_bf16 v8, v221, v241, v8
    v_dot2_f32_bf16 v8, v222, v242, v8
    v_dot2_f32_bf16 v8, v223, v243, v8
    s_nop 2
    v_add_f32_dpp v8, v8, v8 row_ror:8 row_mask:0xf bank_mask:0xf
    s_nop 1
    v_add_f32_dpp v8, v8, v8 row_ror:4 row_mask:0xf bank_mask:0xf
    s_nop 1
    v_add_f32_dpp v8, v8, v8 row_ror:2 row_mask:0xf bank_mask:0xf
    s_nop 1
    v_add_f32_dpp v8, v8, v8 row_ror:1 row_mask:0xf bank_mask:0xf
    v_mul_f32 v8, 3216550459, v8
    v_exp_f32 v8, v8
    s_nop 0
    v_add_f32 v8, 1.0, v8
    v_rcp_f32 v8, v8
    v_add_lshl_u32 v11, s47, v2, 2
    s_mov_b32 s43, 9715712
    v_cmp_eq_u32 vcc, 0, v1
    s_nop 1
    s_and_saveexec_b64 s[52:53], vcc
    buffer_store_dword v8, v11, s[56:59], s43 offen
    s_mov_b64 exec, s[52:53]
    v_cvt_pk_bf16_f32 v194, v120, v121
    v_cvt_pk_bf16_f32 v195, v122, v123
    v_cvt_pk_bf16_f32 v196, v124, v125
    v_cvt_pk_bf16_f32 v197, v126, v127
    v_cvt_pk_bf16_f32 v198, v128, v129
    v_cvt_pk_bf16_f32 v199, v130, v131
    v_cvt_pk_bf16_f32 v200, v132, v133
    v_cvt_pk_bf16_f32 v201, v134, v135
    v_cvt_pk_bf16_f32 v202, v136, v137
    v_cvt_pk_bf16_f32 v203, v138, v139
    s_waitcnt lgkmcnt(0)
    v_mfma_f32_16x16x32_bf16 v[204:207], v[144:147], v[194:197], 0
    v_mfma_f32_16x16x32_bf16 v[208:211], v[154:157], v[194:197], 0
    v_mfma_f32_16x16x32_bf16 v[212:215], v[164:167], v[194:197], 0
    v_mfma_f32_16x16x32_bf16 v[216:219], v[174:177], v[194:197], 0
    v_mfma_f32_16x16x32_bf16 v[220:223], v[184:187], v[194:197], 0
    v_mfma_f32_16x16x32_bf16 v[204:207], v[148:151], v[198:201], v[204:207]
    v_mfma_f32_16x16x32_bf16 v[208:211], v[158:161], v[198:201], v[208:211]
    v_mfma_f32_16x16x32_bf16 v[212:215], v[168:171], v[198:201], v[212:215]
    v_mfma_f32_16x16x32_bf16 v[216:219], v[178:181], v[198:201], v[216:219]
    v_mfma_f32_16x16x32_bf16 v[220:223], v[188:191], v[198:201], v[220:223]
    v_mfma_f32_16x16x16_bf16 v[204:207], v[152:153], v[202:203], v[204:207]
    v_mfma_f32_16x16x16_bf16 v[208:211], v[162:163], v[202:203], v[208:211]
    v_mfma_f32_16x16x16_bf16 v[212:215], v[172:173], v[202:203], v[212:215]
    v_mfma_f32_16x16x16_bf16 v[216:219], v[182:183], v[202:203], v[216:219]
    v_mfma_f32_16x16x16_bf16 v[220:223], v[192:193], v[202:203], v[220:223]
    s_mov_b32 s45, 1069066811
    s_nop 2
    v_max3_f32 v8, v204, v205, v206
    v_min3_f32 v9, v204, v205, v206
    v_max3_f32 v8, v8, v207, v208
    v_min3_f32 v9, v9, v207, v208
    v_max3_f32 v8, v8, v209, v210
    v_min3_f32 v9, v9, v209, v210
    v_max3_f32 v8, v8, v211, v212
    v_min3_f32 v9, v9, v211, v212
    v_max3_f32 v8, v8, v213, v214
    v_min3_f32 v9, v9, v213, v214
    v_max3_f32 v8, v8, v215, v216
    v_min3_f32 v9, v9, v215, v216
    v_max3_f32 v8, v8, v217, v218
    v_min3_f32 v9, v9, v217, v218
    v_max3_f32 v8, v8, v219, v220
    v_min3_f32 v9, v9, v219, v220
    v_max3_f32 v8, v8, v221, v222
    v_min3_f32 v9, v9, v221, v222
    v_max_f32 v8, v8, v223
    v_min_f32 v9, v9, v223
    v_mul_f32 v8, s45, v8
    v_mul_f32 v9, s45, v9
    v_fma_f32 v224, -v204, s45, v9
    v_fma_f32 v204, v204, s45, -v8
    v_fma_f32 v225, -v205, s45, v9
    v_fma_f32 v205, v205, s45, -v8
    v_fma_f32 v226, -v206, s45, v9
    v_fma_f32 v206, v206, s45, -v8
    v_fma_f32 v227, -v207, s45, v9
    v_fma_f32 v207, v207, s45, -v8
    v_fma_f32 v228, -v208, s45, v9
    v_fma_f32 v208, v208, s45, -v8
    v_fma_f32 v229, -v209, s45, v9
    v_fma_f32 v209, v209, s45, -v8
    v_fma_f32 v230, -v210, s45, v9
    v_fma_f32 v210, v210, s45, -v8
    v_fma_f32 v231, -v211, s45, v9
    v_fma_f32 v211, v211, s45, -v8
    v_fma_f32 v232, -v212, s45, v9
    v_fma_f32 v212, v212, s45, -v8
    v_fma_f32 v233, -v213, s45, v9
    v_fma_f32 v213, v213, s45, -v8
    v_fma_f32 v234, -v214, s45, v9
    v_fma_f32 v214, v214, s45, -v8
    v_fma_f32 v235, -v215, s45, v9
    v_fma_f32 v215, v215, s45, -v8
    v_fma_f32 v236, -v216, s45, v9
    v_fma_f32 v216, v216, s45, -v8
    v_fma_f32 v237, -v217, s45, v9
    v_fma_f32 v217, v217, s45, -v8
    v_fma_f32 v238, -v218, s45, v9
    v_fma_f32 v218, v218, s45, -v8
    v_fma_f32 v239, -v219, s45, v9
    v_fma_f32 v219, v219, s45, -v8
    v_fma_f32 v240, -v220, s45, v9
    v_fma_f32 v220, v220, s45, -v8
    v_fma_f32 v241, -v221, s45, v9
    v_fma_f32 v221, v221, s45, -v8
    v_fma_f32 v242, -v222, s45, v9
    v_fma_f32 v222, v222, s45, -v8
    v_fma_f32 v243, -v223, s45, v9
    v_fma_f32 v223, v223, s45, -v8
    v_exp_f32 v204, v204
    v_exp_f32 v224, v224
    v_exp_f32 v205, v205
    v_exp_f32 v225, v225
    v_exp_f32 v206, v206
    v_exp_f32 v226, v226
    v_exp_f32 v207, v207
    v_exp_f32 v227, v227
    v_exp_f32 v208, v208
    v_exp_f32 v228, v228
    v_exp_f32 v209, v209
    v_exp_f32 v229, v229
    v_exp_f32 v210, v210
    v_exp_f32 v230, v230
    v_exp_f32 v211, v211
    v_exp_f32 v231, v231
    v_exp_f32 v212, v212
    v_exp_f32 v232, v232
    v_exp_f32 v213, v213
    v_exp_f32 v233, v233
    v_exp_f32 v214, v214
    v_exp_f32 v234, v234
    v_exp_f32 v215, v215
    v_exp_f32 v235, v235
    v_exp_f32 v216, v216
    v_exp_f32 v236, v236
    v_exp_f32 v217, v217
    v_exp_f32 v237, v237
    v_exp_f32 v218, v218
    v_exp_f32 v238, v238
    v_exp_f32 v219, v219
    v_exp_f32 v239, v239
    v_exp_f32 v220, v220
    v_exp_f32 v240, v240
    v_exp_f32 v221, v221
    v_exp_f32 v241, v241
    v_exp_f32 v222, v222
    v_exp_f32 v242, v242
    v_exp_f32 v223, v223
    v_exp_f32 v243, v243
    v_add_f32 v8, v204, v205
    v_add_f32 v9, v224, v225
    v_add_f32 v8, v8, v206
    v_add_f32 v9, v9, v226
    v_add_f32 v8, v8, v207
    v_add_f32 v9, v9, v227
    v_add_f32 v8, v8, v208
    v_add_f32 v9, v9, v228
    v_add_f32 v8, v8, v209
    v_add_f32 v9, v9, v229
    v_add_f32 v8, v8, v210
    v_add_f32 v9, v9, v230
    v_add_f32 v8, v8, v211
    v_add_f32 v9, v9, v231
    v_add_f32 v8, v8, v212
    v_add_f32 v9, v9, v232
    v_add_f32 v8, v8, v213
    v_add_f32 v9, v9, v233
    v_add_f32 v8, v8, v214
    v_add_f32 v9, v9, v234
    v_add_f32 v8, v8, v215
    v_add_f32 v9, v9, v235
    v_add_f32 v8, v8, v216
    v_add_f32 v9, v9, v236
    v_add_f32 v8, v8, v217
    v_add_f32 v9, v9, v237
    v_add_f32 v8, v8, v218
    v_add_f32 v9, v9, v238
    v_add_f32 v8, v8, v219
    v_add_f32 v9, v9, v239
    v_add_f32 v8, v8, v220
    v_add_f32 v9, v9, v240
    v_add_f32 v8, v8, v221
    v_add_f32 v9, v9, v241
    v_add_f32 v8, v8, v222
    v_add_f32 v9, v9, v242
    v_add_f32 v8, v8, v223
    v_add_f32 v9, v9, v243
    v_rcp_f32 v8, v8
    v_rcp_f32 v9, v9
    v_mul_f32 v204, v8, v204
    v_mul_f32 v224, v9, v224
    v_mul_f32 v205, v8, v205
    v_mul_f32 v225, v9, v225
    v_mul_f32 v206, v8, v206
    v_mul_f32 v226, v9, v226
    v_mul_f32 v207, v8, v207
    v_mul_f32 v227, v9, v227
    v_mul_f32 v208, v8, v208
    v_mul_f32 v228, v9, v228
    v_mul_f32 v209, v8, v209
    v_mul_f32 v229, v9, v229
    v_mul_f32 v210, v8, v210
    v_mul_f32 v230, v9, v230
    v_mul_f32 v211, v8, v211
    v_mul_f32 v231, v9, v231
    v_mul_f32 v212, v8, v212
    v_mul_f32 v232, v9, v232
    v_mul_f32 v213, v8, v213
    v_mul_f32 v233, v9, v233
    v_mul_f32 v214, v8, v214
    v_mul_f32 v234, v9, v234
    v_mul_f32 v215, v8, v215
    v_mul_f32 v235, v9, v235
    v_mul_f32 v216, v8, v216
    v_mul_f32 v236, v9, v236
    v_mul_f32 v217, v8, v217
    v_mul_f32 v237, v9, v237
    v_mul_f32 v218, v8, v218
    v_mul_f32 v238, v9, v238
    v_mul_f32 v219, v8, v219
    v_mul_f32 v239, v9, v239
    v_mul_f32 v220, v8, v220
    v_mul_f32 v240, v9, v240
    v_mul_f32 v221, v8, v221
    v_mul_f32 v241, v9, v241
    v_mul_f32 v222, v8, v222
    v_mul_f32 v242, v9, v242
    v_mul_f32 v223, v8, v223
    v_mul_f32 v243, v9, v243
    v_cvt_pk_bf16_f32 v80, v204, v205
    v_cvt_pk_bf16_f32 v90, v224, v225
    v_cvt_pk_bf16_f32 v81, v206, v207
    v_cvt_pk_bf16_f32 v91, v226, v227
    v_cvt_pk_bf16_f32 v82, v208, v209
    v_cvt_pk_bf16_f32 v92, v228, v229
    v_cvt_pk_bf16_f32 v83, v210, v211
    v_cvt_pk_bf16_f32 v93, v230, v231
    v_cvt_pk_bf16_f32 v84, v212, v213
    v_cvt_pk_bf16_f32 v94, v232, v233
    v_cvt_pk_bf16_f32 v85, v214, v215
    v_cvt_pk_bf16_f32 v95, v234, v235
    v_cvt_pk_bf16_f32 v86, v216, v217
    v_cvt_pk_bf16_f32 v96, v236, v237
    v_cvt_pk_bf16_f32 v87, v218, v219
    v_cvt_pk_bf16_f32 v97, v238, v239
    v_cvt_pk_bf16_f32 v88, v220, v221
    v_cvt_pk_bf16_f32 v98, v240, v241
    v_cvt_pk_bf16_f32 v89, v222, v223
    v_cvt_pk_bf16_f32 v99, v242, v243
    v_add_u32 v11, s46, v1
    v_add_u32 v11, 16, v11
    v_mul_u32_u24 v12, 10240, v14
    v_add_lshl_u32 v7, v12, v11, 4
    s_mov_b32 s43, 9723904
    buffer_store_dwordx4 v[80:83], v7, s[56:59], s43 offen offset:0
    s_add_u32 s43, s43, 32768
    buffer_store_dwordx4 v[84:87], v7, s[56:59], s43 offen offset:0
    s_add_u32 s43, s43, 32768
    buffer_store_dwordx4 v[88:91], v7, s[56:59], s43 offen offset:0
    s_add_u32 s43, s43, 32768
    buffer_store_dwordx4 v[92:95], v7, s[56:59], s43 offen offset:0
    s_add_u32 s43, s43, 32768
    buffer_store_dwordx4 v[96:99], v7, s[56:59], s43 offen offset:0
K1_FIN:
K1_END:
    s_endpgm
.globl k2_kernel
.p2align 8
.type k2_kernel,@function
k2_kernel:
    s_cmp_ge_u32 s2, 256
    s_cbranch_scc1 K2_END
    s_load_dwordx2 s[40:41], s[0:1], 80
    s_load_dwordx2 s[48:49], s[0:1], 16
    s_load_dwordx2 s[50:51], s[0:1], 48
    s_and_b32 s42, s2, 7
    s_lshr_b32 s43, s2, 3
    s_lshl_b32 s42, s42, 2
    s_and_b32 s44, s43, 3
    s_add_u32 s20, s42, s44
    s_lshr_b32 s21, s43, 2
    v_lshrrev_b32 v11, 6, v0
    v_mov_b32 v15, v0
    v_and_b32 v0, 63, v0
    v_readfirstlane_b32 s23, v11
    v_lshlrev_b32 v1, 4, v0
    s_nop 0
    s_and_b32 s22, s23, 7
    s_lshr_b32 s35, s23, 3
    s_mul_i32 s42, s20, 98304
    s_lshl_b32 s43, s35, 14
    s_add_u32 s42, s42, s43
    s_mul_i32 s57, s35, 14784
    s_add_u32 s57, s57, 23552
    s_add_u32 s44, s22, 0
    s_cmp_lt_u32 s44, 6
    s_mov_b32 s45, 6291456
    s_cselect_b32 s45, 3145728, s45
    s_lshr_b32 s46, s44, 1
    s_and_b32 s47, s44, 1
    s_mul_i32 s27, s46, 2112
    s_lshl_b32 s47, s47, 10
    s_add_u32 s27, s27, s47
    s_add_u32 s27, s27, s57
    s_cmp_ge_u32 s46, 3
    s_cselect_b32 s44, 3, 0
    s_sub_u32 s46, s46, s44
    s_lshl_b32 s46, s46, 15
    s_add_u32 s45, s45, s46
    s_add_u32 s45, s45, s47
    s_add_u32 s24, s45, s42
    s_add_u32 s44, s22, 8
    s_cmp_lt_u32 s44, 6
    s_mov_b32 s45, 6291456
    s_cselect_b32 s45, 3145728, s45
    s_lshr_b32 s46, s44, 1
    s_and_b32 s47, s44, 1
    s_mul_i32 s28, s46, 2112
    s_lshl_b32 s47, s47, 10
    s_add_u32 s28, s28, s47
    s_add_u32 s28, s28, s57
    s_cmp_ge_u32 s46, 3
    s_cselect_b32 s44, 3, 0
    s_sub_u32 s46, s46, s44
    s_lshl_b32 s46, s46, 15
    s_add_u32 s45, s45, s46
    s_add_u32 s45, s45, s47
    s_add_u32 s25, s45, s42
    s_waitcnt lgkmcnt(0)
    s_mov_b32 s12, s40
    s_and_b32 s13, s41, 0xffff
    s_mov_b32 s14, 23568384
    s_mov_b32 s15, 0x00020000
    s_add_u32 m0, s27, 0
    s_nop 0
    buffer_load_dwordx4 v1, s[12:15], s24 offen lds
    s_add_u32 s24, s24, 2048
    s_cmp_ge_u32 s22, 4
    s_cbranch_scc1 K2_D0
    s_add_u32 m0, s28, 0
    s_nop 0
    buffer_load_dwordx4 v1, s[12:15], s25 offen lds
    s_add_u32 s25, s25, 2048
K2_D0:
    v_and_b32 v11, 31, v0
    v_lshrrev_b32 v12, 5, v0
    s_lshl_b32 s43, s21, 8
    s_lshl_b32 s44, s22, 5
    s_add_u32 s46, s43, s44
    v_add_u32 v13, s46, v11
    s_mul_i32 s42, s20, 98304
    v_lshlrev_b32 v14, 4, v13
    v_lshl_add_u32 v126, v12, 15, v14
    buffer_load_dwordx4 v[120:123], v126, s[12:15], s42 offen
    v_lshl_add_u32 v126, v12, 3, v14
    s_add_u32 s43, s42, 65536
    buffer_load_dwordx2 v[124:125], v126, s[12:15], s43 offen
    v_lshlrev_b32 v126, 2, v13
    s_lshl_b32 s43, s20, 13
    s_add_u32 s43, s43, 9437184
    buffer_load_dword v16, v126, s[12:15], s43 offen
    s_lshl_b32 s43, s20, 8
    s_add_u32 s43, s43, 9699328
    v_lshlrev_b32 v126, 2, v0
    buffer_load_dword v17, v126, s[12:15], s43 offen
    s_add_u32 m0, s27, 29568
    s_nop 0
    buffer_load_dwordx4 v1, s[12:15], s24 offen lds
    s_add_u32 s24, s24, 2048
    s_cmp_ge_u32 s22, 4
    s_cbranch_scc1 K2_D1
    s_add_u32 m0, s28, 29568
    s_nop 0
    buffer_load_dwordx4 v1, s[12:15], s25 offen lds
    s_add_u32 s25, s25, 2048
K2_D1:
    v_mul_u32_u24 v13, 497, v15
    v_lshrrev_b32 v13, 16, v13
    v_mul_u32_u24 v14, 132, v13
    v_sub_u32 v14, v15, v14
    v_mul_u32_u24 v13, 14784, v13
    v_lshl_add_u32 v13, v14, 4, v13
    v_mov_b32 v32, 0
    v_mov_b32 v33, 0
    v_mov_b32 v34, 0
    v_mov_b32 v35, 0
    v_cmp_gt_u32 vcc, 792, v15
    s_nop 1
    s_and_saveexec_b64 s[52:53], vcc
    ds_write_b128 v13, v[32:35] offset:36224
    s_mov_b64 exec, s[52:53]
    v_lshlrev_b32 v14, 4, v11
    v_mul_u32_u24 v13, 2112, v12
    v_add3_u32 v2, v14, v13, s57
    v_lshl_add_u32 v3, v12, 3, v14
    v_add_u32 v3, 4224, v3
    v_add_u32 v3, s57, v3
    v_and_b32 v13, 15, v0
    v_lshrrev_b32 v13, 2, v13
    v_lshl_add_u32 v13, v12, 2, v13
    v_lshlrev_b32 v13, 4, v13
    v_bfe_u32 v14, v0, 1, 1
    v_bfe_u32 v126, v0, 4, 1
    v_lshl_add_u32 v14, v126, 1, v14
    v_mul_u32_u24 v14, 2112, v14
    v_add_u32 v13, v13, v14
    v_and_b32 v14, 1, v0
    v_lshl_add_u32 v4, v14, 3, v13
    v_add_u32 v4, 6336, v4
    v_add_u32 v4, s57, v4
    v_mov_b32 v72, 0
    v_mov_b32 v73, 0
    v_mov_b32 v74, 0
    v_mov_b32 v75, 0
    v_mov_b32 v76, 0
    v_mov_b32 v77, 0
    v_mov_b32 v78, 0
    v_mov_b32 v79, 0
    v_mov_b32 v80, 0
    v_mov_b32 v81, 0
    v_mov_b32 v82, 0
    v_mov_b32 v83, 0
    v_mov_b32 v84, 0
    v_mov_b32 v85, 0
    v_mov_b32 v86, 0
    v_mov_b32 v87, 0
    s_waitcnt vmcnt(0)
    v_max_f32_dpp v17, v17, v17 row_ror:8 row_mask:0xf bank_mask:0xf
    s_nop 1
    v_max_f32_dpp v17, v17, v17 row_ror:4 row_mask:0xf bank_mask:0xf
    s_nop 1
    v_max_f32_dpp v17, v17, v17 row_ror:2 row_mask:0xf bank_mask:0xf
    s_nop 1
    v_max_f32_dpp v17, v17, v17 row_ror:1 row_mask:0xf bank_mask:0xf
    s_nop 0
    v_readlane_b32 s42, v17, 0
    v_readlane_b32 s43, v17, 16
    v_readlane_b32 s44, v17, 32
    v_readlane_b32 s45, v17, 48
    s_max_u32 s42, s42, s43
    s_nop 0
    s_max_u32 s44, s44, s45
    s_max_u32 s42, s42, s44
    v_sqrt_f32 v11, s42
    s_nop 0
    v_mul_f32 v11, v11, v16
    v_cmp_lt_f32 vcc, 1112014848, v11
    s_nop 1
    s_cmp_lg_u64 vcc, 0
    s_cselect_b32 s42, 1, 0
    v_mov_b32 v13, s42
    s_lshl_b32 s43, s23, 2
    v_mov_b32 v14, s43
    ds_write_b32 v14, v13 offset:2816
    v_sub_f32 v11, 0, v11
    v_cvt_pk_bf16_f32 v11, v11, v11
    v_and_b32 v11, 0xffff, v11
    s_waitcnt lgkmcnt(0)
    s_barrier
    v_and_b32 v13, 15, v0
    v_lshlrev_b32 v13, 2, v13
    ds_read_b32 v14, v13 offset:2816
    s_waitcnt lgkmcnt(0)
    v_cmp_ne_u32 vcc, 0, v14
    s_nop 1
    s_cmp_lg_u64 vcc, 0
    s_cselect_b32 s59, 1, 0
    s_cbranch_scc1 K2_NOM
    v_cmp_eq_u32 vcc, 1, v12
    s_nop 1
    v_cndmask_b32 v124, v124, v11, vcc
K2_NOM:
    s_mov_b32 s30, 0
    s_mov_b32 s31, 29568
    s_mov_b32 s32, 59136
    s_mov_b32 s33, 0
    ds_read_b128 v[88:91], v2 offset:0
    ds_read_b64 v[92:93], v3 offset:0
    ds_read_b128 v[96:99], v2 offset:512
    ds_read_b64 v[100:101], v3 offset:512
    ds_read_b64_tr_b16 v[104:105], v4 offset:0
    ds_read_b64_tr_b16 v[106:107], v4 offset:128
    ds_read_b64_tr_b16 v[108:109], v4 offset:256
    ds_read_b64_tr_b16 v[110:111], v4 offset:384
    s_waitcnt lgkmcnt(0)
    v_mfma_f32_32x32x16_bf16 v[32:47], v[88:91], v[120:123], 0
    v_mfma_f32_32x32x8_bf16 v[32:47], v[92:93], v[124:125], v[32:47]
    v_mov_b32 v12, 4284592614
    s_cmp_lg_u32 s59, 0
    s_cbranch_scc1 K2_SLOW
    s_add_u32 m0, s27, s32
    s_nop 0
    buffer_load_dwordx4 v1, s[12:15], s24 offen lds
    s_add_u32 s24, s24, 2048
    s_cmp_ge_u32 s22, 4
    s_cbranch_scc1 K2_D2
    s_add_u32 m0, s28, s32
    s_nop 0
    buffer_load_dwordx4 v1, s[12:15], s25 offen lds
    s_add_u32 s25, s25, 2048
K2_D2:
    s_mul_i32 s42, s20, 53760
    s_add_u32 s42, s42, 14966784
    v_lshlrev_b32 v14, 2, v15
    v_cmp_gt_u32 vcc, 840, v15
    s_nop 1
    s_and_saveexec_b64 s[52:53], vcc
    s_cbranch_execz K2_NOKV
    buffer_load_dword v16, v14, s[12:15], s42 offen
    s_add_u32 s42, s42, 3360
    buffer_load_dword v17, v14, s[12:15], s42 offen
    s_add_u32 s42, s42, 3360
    buffer_load_dword v18, v14, s[12:15], s42 offen
    s_add_u32 s42, s42, 3360
    buffer_load_dword v19, v14, s[12:15], s42 offen
    s_add_u32 s42, s42, 3360
    buffer_load_dword v20, v14, s[12:15], s42 offen
    s_add_u32 s42, s42, 3360
    buffer_load_dword v21, v14, s[12:15], s42 offen
    s_add_u32 s42, s42, 3360
    buffer_load_dword v22, v14, s[12:15], s42 offen
    s_add_u32 s42, s42, 3360
    buffer_load_dword v23, v14, s[12:15], s42 offen
    s_add_u32 s42, s42, 3360
    buffer_load_dword v24, v14, s[12:15], s42 offen
    s_add_u32 s42, s42, 3360
    buffer_load_dword v25, v14, s[12:15], s42 offen
    s_add_u32 s42, s42, 3360
    buffer_load_dword v26, v14, s[12:15], s42 offen
    s_add_u32 s42, s42, 3360
    buffer_load_dword v27, v14, s[12:15], s42 offen
    s_add_u32 s42, s42, 3360
    buffer_load_dword v28, v14, s[12:15], s42 offen
    s_add_u32 s42, s42, 3360
    buffer_load_dword v29, v14, s[12:15], s42 offen
    s_add_u32 s42, s42, 3360
    buffer_load_dword v30, v14, s[12:15], s42 offen
    s_add_u32 s42, s42, 3360
    buffer_load_dword v31, v14, s[12:15], s42 offen
    s_add_u32 s42, s42, 3360
K2_NOKV:
    s_mov_b64 exec, s[52:53]
    s_mul_i32 s42, s20, 163840
    s_lshl_b32 s43, s21, 12
    s_add_u32 s42, s42, s43
    s_add_u32 s42, s42, 9723904
    s_add_u32 s43, s23, 0
    s_lshr_b32 s44, s43, 2
    s_and_b32 s45, s43, 3
    s_lshl_b32 s47, s44, 15
    s_lshl_b32 s45, s45, 10
    s_add_u32 s47, s47, s45
    s_add_u32 s47, s47, s42
    s_lshl_b32 s44, s43, 10
    s_add_u32 m0, s44, 3072
    s_nop 0
    buffer_load_dwordx4 v1, s[12:15], s47 offen lds
    s_cmp_ge_u32 s23, 4
    s_cbranch_scc1 K2_NOPH
    s_add_u32 s43, s23, 16
    s_lshr_b32 s44, s43, 2
    s_and_b32 s45, s43, 3
    s_lshl_b32 s47, s44, 15
    s_lshl_b32 s45, s45, 10
    s_add_u32 s47, s47, s45
    s_add_u32 s47, s47, s42
    s_lshl_b32 s44, s43, 10
    s_add_u32 m0, s44, 3072
    s_nop 0
    buffer_load_dwordx4 v1, s[12:15], s47 offen lds
K2_NOPH:
    v_add_u32 v5, s30, v2
    v_add_u32 v8, s31, v2
    v_add_u32 v6, s30, v3
    v_add_u32 v9, s31, v3
    v_add_u32 v7, s30, v4
    v_add_u32 v10, s31, v4
    s_waitcnt lgkmcnt(0)
    ds_read_b128 v[88:91], v5 offset:1024
    ds_read_b64 v[92:93], v6 offset:1024
    ds_read_b64_tr_b16 v[112:113], v7 offset:512
    ds_read_b64_tr_b16 v[114:115], v7 offset:640
    ds_read_b64_tr_b16 v[116:117], v7 offset:768
    ds_read_b64_tr_b16 v[118:119], v7 offset:896
    v_mfma_f32_32x32x16_bf16 v[48:63], v[96:99], v[120:123], 0
    v_exp_f32 v32, v32
    v_exp_f32 v33, v33
    v_exp_f32 v34, v34
    v_exp_f32 v35, v35
    v_mfma_f32_32x32x8_bf16 v[48:63], v[100:101], v[124:125], v[48:63]
    v_cvt_pk_bf16_f32 v64, v32, v33
    v_cvt_pk_bf16_f32 v65, v34, v35
    v_exp_f32 v36, v36
    v_exp_f32 v37, v37
    v_exp_f32 v38, v38
    v_exp_f32 v39, v39
    v_cvt_pk_bf16_f32 v66, v36, v37
    v_cvt_pk_bf16_f32 v67, v38, v39
    v_exp_f32 v40, v40
    v_exp_f32 v41, v41
    v_exp_f32 v42, v42
    v_exp_f32 v43, v43
    v_mfma_f32_32x32x16_bf16 v[72:87], v[104:107], v[64:67], v[72:87]
    v_cvt_pk_bf16_f32 v68, v40, v41
    v_cvt_pk_bf16_f32 v69, v42, v43
    v_exp_f32 v44, v44
    v_exp_f32 v45, v45
    v_exp_f32 v46, v46
    v_exp_f32 v47, v47
    v_cvt_pk_bf16_f32 v70, v44, v45
    v_cvt_pk_bf16_f32 v71, v46, v47
    s_nop 1
    v_mfma_f32_32x32x16_bf16 v[72:87], v[108:111], v[68:71], v[72:87]
    s_waitcnt lgkmcnt(0)
    ds_read_b128 v[96:99], v5 offset:1536
    ds_read_b64 v[100:101], v6 offset:1536
    ds_read_b64_tr_b16 v[104:105], v7 offset:1024
    ds_read_b64_tr_b16 v[106:107], v7 offset:1152
    ds_read_b64_tr_b16 v[108:109], v7 offset:1280
    ds_read_b64_tr_b16 v[110:111], v7 offset:1408
    v_mfma_f32_32x32x16_bf16 v[32:47], v[88:91], v[120:123], 0
    v_exp_f32 v48, v48
    v_exp_f32 v49, v49
    v_exp_f32 v50, v50
    v_exp_f32 v51, v51
    v_mfma_f32_32x32x8_bf16 v[32:47], v[92:93], v[124:125], v[32:47]
    v_cvt_pk_bf16_f32 v64, v48, v49
    v_cvt_pk_bf16_f32 v65, v50, v51
    v_exp_f32 v52, v52
    v_exp_f32 v53, v53
    v_exp_f32 v54, v54
    v_exp_f32 v55, v55
    v_cvt_pk_bf16_f32 v66, v52, v53
    v_cvt_pk_bf16_f32 v67, v54, v55
    v_exp_f32 v56, v56
    v_exp_f32 v57, v57
    v_exp_f32 v58, v58
    v_exp_f32 v59, v59
    v_mfma_f32_32x32x16_bf16 v[72:87], v[112:115], v[64:67], v[72:87]
    v_cvt_pk_bf16_f32 v68, v56, v57
    v_cvt_pk_bf16_f32 v69, v58, v59
    v_exp_f32 v60, v60
    v_exp_f32 v61, v61
    v_exp_f32 v62, v62
    v_exp_f32 v63, v63
    v_cvt_pk_bf16_f32 v70, v60, v61
    v_cvt_pk_bf16_f32 v71, v62, v63
    s_nop 1
    v_mfma_f32_32x32x16_bf16 v[72:87], v[116:119], v[68:71], v[72:87]
    s_waitcnt lgkmcnt(0)
    ds_read_b128 v[88:91], v8 offset:0
    ds_read_b64 v[92:93], v9 offset:0
    ds_read_b64_tr_b16 v[112:113], v7 offset:1536
    ds_read_b64_tr_b16 v[114:115], v7 offset:1664
    ds_read_b64_tr_b16 v[116:117], v7 offset:1792
    ds_read_b64_tr_b16 v[118:119], v7 offset:1920
    v_mfma_f32_32x32x16_bf16 v[48:63], v[96:99], v[120:123], 0
    v_exp_f32 v32, v32
    v_exp_f32 v33, v33
    v_exp_f32 v34, v34
    v_exp_f32 v35, v35
    v_mfma_f32_32x32x8_bf16 v[48:63], v[100:101], v[124:125], v[48:63]
    v_cvt_pk_bf16_f32 v64, v32, v33
    v_cvt_pk_bf16_f32 v65, v34, v35
    v_exp_f32 v36, v36
    v_exp_f32 v37, v37
    v_exp_f32 v38, v38
    v_exp_f32 v39, v39
    v_cvt_pk_bf16_f32 v66, v36, v37
    v_cvt_pk_bf16_f32 v67, v38, v39
    v_exp_f32 v40, v40
    v_exp_f32 v41, v41
    v_exp_f32 v42, v42
    v_exp_f32 v43, v43
    v_mfma_f32_32x32x16_bf16 v[72:87], v[104:107], v[64:67], v[72:87]
    v_cvt_pk_bf16_f32 v68, v40, v41
    v_cvt_pk_bf16_f32 v69, v42, v43
    v_exp_f32 v44, v44
    v_exp_f32 v45, v45
    v_exp_f32 v46, v46
    v_exp_f32 v47, v47
    v_cvt_pk_bf16_f32 v70, v44, v45
    v_cvt_pk_bf16_f32 v71, v46, v47
    s_nop 1
    v_mfma_f32_32x32x16_bf16 v[72:87], v[108:111], v[68:71], v[72:87]
    s_waitcnt lgkmcnt(0)
    ds_read_b128 v[96:99], v8 offset:512
    ds_read_b64 v[100:101], v9 offset:512
    ds_read_b64_tr_b16 v[104:105], v10 offset:0
    ds_read_b64_tr_b16 v[106:107], v10 offset:128
    ds_read_b64_tr_b16 v[108:109], v10 offset:256
    ds_read_b64_tr_b16 v[110:111], v10 offset:384
    v_mfma_f32_32x32x16_bf16 v[32:47], v[88:91], v[120:123], 0
    v_exp_f32 v48, v48
    v_exp_f32 v49, v49
    v_exp_f32 v50, v50
    v_exp_f32 v51, v51
    v_mfma_f32_32x32x8_bf16 v[32:47], v[92:93], v[124:125], v[32:47]
    v_cvt_pk_bf16_f32 v64, v48, v49
    v_cvt_pk_bf16_f32 v65, v50, v51
    v_exp_f32 v52, v52
    v_exp_f32 v53, v53
    v_exp_f32 v54, v54
    v_exp_f32 v55, v55
    v_cvt_pk_bf16_f32 v66, v52, v53
    v_cvt_pk_bf16_f32 v67, v54, v55
    v_exp_f32 v56, v56
    v_exp_f32 v57, v57
    v_exp_f32 v58, v58
    v_exp_f32 v59, v59
    v_mfma_f32_32x32x16_bf16 v[72:87], v[112:115], v[64:67], v[72:87]
    v_cvt_pk_bf16_f32 v68, v56, v57
    v_cvt_pk_bf16_f32 v69, v58, v59
    v_exp_f32 v60, v60
    v_exp_f32 v61, v61
    v_exp_f32 v62, v62
    v_exp_f32 v63, v63
    v_cvt_pk_bf16_f32 v70, v60, v61
    v_cvt_pk_bf16_f32 v71, v62, v63
    s_nop 1
    v_mfma_f32_32x32x16_bf16 v[72:87], v[116:119], v[68:71], v[72:87]
    s_mov_b32 s34, s30
    s_mov_b32 s30, s31
    s_mov_b32 s31, s32
    s_mov_b32 s32, s34
    s_add_u32 s33, s33, 1
    s_waitcnt vmcnt(0)
    v_add_f32 v16, v16, v17
    v_add_f32 v16, v16, v18
    v_add_f32 v16, v16, v19
    v_add_f32 v16, v16, v20
    v_add_f32 v16, v16, v21
    v_add_f32 v16, v16, v22
    v_add_f32 v16, v16, v23
    v_add_f32 v16, v16, v24
    v_add_f32 v16, v16, v25
    v_add_f32 v16, v16, v26
    v_add_f32 v16, v16, v27
    v_add_f32 v16, v16, v28
    v_add_f32 v16, v16, v29
    v_add_f32 v16, v16, v30
    v_add_f32 v16, v16, v31
    v_cvt_pk_bf16_f32 v16, v16, v16
    v_lshlrev_b32 v14, 1, v15
    v_cmp_gt_u32 vcc, 840, v15
    s_nop 1
    s_and_saveexec_b64 s[52:53], vcc
    ds_write_b16 v14, v16 offset:0
    s_mov_b64 exec, s[52:53]
    s_waitcnt lgkmcnt(0)
    s_barrier
    s_add_u32 m0, s27, s32
    s_nop 0
    buffer_load_dwordx4 v1, s[12:15], s24 offen lds
    s_add_u32 s24, s24, 2048
    s_cmp_ge_u32 s22, 4
    s_cbranch_scc1 K2_D3
    s_add_u32 m0, s28, s32
    s_nop 0
    buffer_load_dwordx4 v1, s[12:15], s25 offen lds
    s_add_u32 s25, s25, 2048
K2_D3:
    v_add_u32 v5, s30, v2
    v_add_u32 v8, s31, v2
    v_add_u32 v6, s30, v3
    v_add_u32 v9, s31, v3
    v_add_u32 v7, s30, v4
    v_add_u32 v10, s31, v4
    s_waitcnt lgkmcnt(0)
    ds_read_b128 v[88:91], v5 offset:1024
    ds_read_b64 v[92:93], v6 offset:1024
    ds_read_b64_tr_b16 v[112:113], v7 offset:512
    ds_read_b64_tr_b16 v[114:115], v7 offset:640
    ds_read_b64_tr_b16 v[116:117], v7 offset:768
    ds_read_b64_tr_b16 v[118:119], v7 offset:896
    v_mfma_f32_32x32x16_bf16 v[48:63], v[96:99], v[120:123], 0
    v_exp_f32 v32, v32
    v_exp_f32 v33, v33
    v_exp_f32 v34, v34
    v_exp_f32 v35, v35
    v_mfma_f32_32x32x8_bf16 v[48:63], v[100:101], v[124:125], v[48:63]
    v_cvt_pk_bf16_f32 v64, v32, v33
    v_cvt_pk_bf16_f32 v65, v34, v35
    v_exp_f32 v36, v36
    v_exp_f32 v37, v37
    v_exp_f32 v38, v38
    v_exp_f32 v39, v39
    v_cvt_pk_bf16_f32 v66, v36, v37
    v_cvt_pk_bf16_f32 v67, v38, v39
    v_exp_f32 v40, v40
    v_exp_f32 v41, v41
    v_exp_f32 v42, v42
    v_exp_f32 v43, v43
    v_mfma_f32_32x32x16_bf16 v[72:87], v[104:107], v[64:67], v[72:87]
    v_cvt_pk_bf16_f32 v68, v40, v41
    v_cvt_pk_bf16_f32 v69, v42, v43
    v_exp_f32 v44, v44
    v_exp_f32 v45, v45
    v_exp_f32 v46, v46
    v_exp_f32 v47, v47
    v_cvt_pk_bf16_f32 v70, v44, v45
    v_cvt_pk_bf16_f32 v71, v46, v47
    s_nop 1
    v_mfma_f32_32x32x16_bf16 v[72:87], v[108:111], v[68:71], v[72:87]
    s_waitcnt lgkmcnt(0)
    ds_read_b128 v[96:99], v5 offset:1536
    ds_read_b64 v[100:101], v6 offset:1536
    ds_read_b64_tr_b16 v[104:105], v7 offset:1024
    ds_read_b64_tr_b16 v[106:107], v7 offset:1152
    ds_read_b64_tr_b16 v[108:109], v7 offset:1280
    ds_read_b64_tr_b16 v[110:111], v7 offset:1408
    v_mfma_f32_32x32x16_bf16 v[32:47], v[88:91], v[120:123], 0
    v_exp_f32 v48, v48
    v_exp_f32 v49, v49
    v_exp_f32 v50, v50
    v_exp_f32 v51, v51
    v_mfma_f32_32x32x8_bf16 v[32:47], v[92:93], v[124:125], v[32:47]
    v_cvt_pk_bf16_f32 v64, v48, v49
    v_cvt_pk_bf16_f32 v65, v50, v51
    v_exp_f32 v52, v52
    v_exp_f32 v53, v53
    v_exp_f32 v54, v54
    v_exp_f32 v55, v55
    v_cvt_pk_bf16_f32 v66, v52, v53
    v_cvt_pk_bf16_f32 v67, v54, v55
    v_exp_f32 v56, v56
    v_exp_f32 v57, v57
    v_exp_f32 v58, v58
    v_exp_f32 v59, v59
    v_mfma_f32_32x32x16_bf16 v[72:87], v[112:115], v[64:67], v[72:87]
    v_cvt_pk_bf16_f32 v68, v56, v57
    v_cvt_pk_bf16_f32 v69, v58, v59
    v_exp_f32 v60, v60
    v_exp_f32 v61, v61
    v_exp_f32 v62, v62
    v_exp_f32 v63, v63
    v_cvt_pk_bf16_f32 v70, v60, v61
    v_cvt_pk_bf16_f32 v71, v62, v63
    s_nop 1
    v_mfma_f32_32x32x16_bf16 v[72:87], v[116:119], v[68:71], v[72:87]
    s_waitcnt lgkmcnt(0)
    ds_read_b128 v[88:91], v8 offset:0
    ds_read_b64 v[92:93], v9 offset:0
    ds_read_b64_tr_b16 v[112:113], v7 offset:1536
    ds_read_b64_tr_b16 v[114:115], v7 offset:1664
    ds_read_b64_tr_b16 v[116:117], v7 offset:1792
    ds_read_b64_tr_b16 v[118:119], v7 offset:1920
    v_mfma_f32_32x32x16_bf16 v[48:63], v[96:99], v[120:123], 0
    v_exp_f32 v32, v32
    v_exp_f32 v33, v33
    v_exp_f32 v34, v34
    v_exp_f32 v35, v35
    v_mfma_f32_32x32x8_bf16 v[48:63], v[100:101], v[124:125], v[48:63]
    v_cvt_pk_bf16_f32 v64, v32, v33
    v_cvt_pk_bf16_f32 v65, v34, v35
    v_exp_f32 v36, v36
    v_exp_f32 v37, v37
    v_exp_f32 v38, v38
    v_exp_f32 v39, v39
    v_cvt_pk_bf16_f32 v66, v36, v37
    v_cvt_pk_bf16_f32 v67, v38, v39
    v_exp_f32 v40, v40
    v_exp_f32 v41, v41
    v_exp_f32 v42, v42
    v_exp_f32 v43, v43
    v_mfma_f32_32x32x16_bf16 v[72:87], v[104:107], v[64:67], v[72:87]
    v_cvt_pk_bf16_f32 v68, v40, v41
    v_cvt_pk_bf16_f32 v69, v42, v43
    v_exp_f32 v44, v44
    v_exp_f32 v45, v45
    v_exp_f32 v46, v46
    v_exp_f32 v47, v47
    v_cvt_pk_bf16_f32 v70, v44, v45
    v_cvt_pk_bf16_f32 v71, v46, v47
    s_nop 1
    v_mfma_f32_32x32x16_bf16 v[72:87], v[108:111], v[68:71], v[72:87]
    s_waitcnt lgkmcnt(0)
    ds_read_b128 v[96:99], v8 offset:512
    ds_read_b64 v[100:101], v9 offset:512
    ds_read_b64_tr_b16 v[104:105], v10 offset:0
    ds_read_b64_tr_b16 v[106:107], v10 offset:128
    ds_read_b64_tr_b16 v[108:109], v10 offset:256
    ds_read_b64_tr_b16 v[110:111], v10 offset:384
    v_mfma_f32_32x32x16_bf16 v[32:47], v[88:91], v[120:123], 0
    v_exp_f32 v48, v48
    v_exp_f32 v49, v49
    v_exp_f32 v50, v50
    v_exp_f32 v51, v51
    v_mfma_f32_32x32x8_bf16 v[32:47], v[92:93], v[124:125], v[32:47]
    v_cvt_pk_bf16_f32 v64, v48, v49
    v_cvt_pk_bf16_f32 v65, v50, v51
    v_exp_f32 v52, v52
    v_exp_f32 v53, v53
    v_exp_f32 v54, v54
    v_exp_f32 v55, v55
    v_cvt_pk_bf16_f32 v66, v52, v53
    v_cvt_pk_bf16_f32 v67, v54, v55
    v_exp_f32 v56, v56
    v_exp_f32 v57, v57
    v_exp_f32 v58, v58
    v_exp_f32 v59, v59
    v_mfma_f32_32x32x16_bf16 v[72:87], v[112:115], v[64:67], v[72:87]
    v_cvt_pk_bf16_f32 v68, v56, v57
    v_cvt_pk_bf16_f32 v69, v58, v59
    v_exp_f32 v60, v60
    v_exp_f32 v61, v61
    v_exp_f32 v62, v62
    v_exp_f32 v63, v63
    v_cvt_pk_bf16_f32 v70, v60, v61
    v_cvt_pk_bf16_f32 v71, v62, v63
    s_nop 1
    v_mfma_f32_32x32x16_bf16 v[72:87], v[116:119], v[68:71], v[72:87]
    s_mov_b32 s34, s30
    s_mov_b32 s30, s31
    s_mov_b32 s31, s32
    s_mov_b32 s32, s34
    s_add_u32 s33, s33, 1
K2_LOOP:
    s_waitcnt vmcnt(0)
    s_barrier
    s_cmp_ge_u32 s33, 6
    s_cbranch_scc1 K2_NODMA
    s_add_u32 m0, s27, s32
    s_nop 0
    buffer_load_dwordx4 v1, s[12:15], s24 offen lds
    s_add_u32 s24, s24, 2048
    s_cmp_ge_u32 s22, 4
    s_cbranch_scc1 K2_D4
    s_add_u32 m0, s28, s32
    s_nop 0
    buffer_load_dwordx4 v1, s[12:15], s25 offen lds
    s_add_u32 s25, s25, 2048
K2_D4:
K2_NODMA:
    v_add_u32 v5, s30, v2
    v_add_u32 v8, s31, v2
    v_add_u32 v6, s30, v3
    v_add_u32 v9, s31, v3
    v_add_u32 v7, s30, v4
    v_add_u32 v10, s31, v4
    s_waitcnt lgkmcnt(0)
    ds_read_b128 v[88:91], v5 offset:1024
    ds_read_b64 v[92:93], v6 offset:1024
    ds_read_b64_tr_b16 v[112:113], v7 offset:512
    ds_read_b64_tr_b16 v[114:115], v7 offset:640
    ds_read_b64_tr_b16 v[116:117], v7 offset:768
    ds_read_b64_tr_b16 v[118:119], v7 offset:896
    v_mfma_f32_32x32x16_bf16 v[48:63], v[96:99], v[120:123], 0
    v_exp_f32 v32, v32
    v_exp_f32 v33, v33
    v_exp_f32 v34, v34
    v_exp_f32 v35, v35
    v_mfma_f32_32x32x8_bf16 v[48:63], v[100:101], v[124:125], v[48:63]
    v_cvt_pk_bf16_f32 v64, v32, v33
    v_cvt_pk_bf16_f32 v65, v34, v35
    v_exp_f32 v36, v36
    v_exp_f32 v37, v37
    v_exp_f32 v38, v38
    v_exp_f32 v39, v39
    v_cvt_pk_bf16_f32 v66, v36, v37
    v_cvt_pk_bf16_f32 v67, v38, v39
    v_exp_f32 v40, v40
    v_exp_f32 v41, v41
    v_exp_f32 v42, v42
    v_exp_f32 v43, v43
    v_mfma_f32_32x32x16_bf16 v[72:87], v[104:107], v[64:67], v[72:87]
    v_cvt_pk_bf16_f32 v68, v40, v41
    v_cvt_pk_bf16_f32 v69, v42, v43
    v_exp_f32 v44, v44
    v_exp_f32 v45, v45
    v_exp_f32 v46, v46
    v_exp_f32 v47, v47
    v_cvt_pk_bf16_f32 v70, v44, v45
    v_cvt_pk_bf16_f32 v71, v46, v47
    s_nop 1
    v_mfma_f32_32x32x16_bf16 v[72:87], v[108:111], v[68:71], v[72:87]
    s_waitcnt lgkmcnt(0)
    ds_read_b128 v[96:99], v5 offset:1536
    ds_read_b64 v[100:101], v6 offset:1536
    ds_read_b64_tr_b16 v[104:105], v7 offset:1024
    ds_read_b64_tr_b16 v[106:107], v7 offset:1152
    ds_read_b64_tr_b16 v[108:109], v7 offset:1280
    ds_read_b64_tr_b16 v[110:111], v7 offset:1408
    v_mfma_f32_32x32x16_bf16 v[32:47], v[88:91], v[120:123], 0
    v_exp_f32 v48, v48
    v_exp_f32 v49, v49
    v_exp_f32 v50, v50
    v_exp_f32 v51, v51
    v_mfma_f32_32x32x8_bf16 v[32:47], v[92:93], v[124:125], v[32:47]
    v_cvt_pk_bf16_f32 v64, v48, v49
    v_cvt_pk_bf16_f32 v65, v50, v51
    v_exp_f32 v52, v52
    v_exp_f32 v53, v53
    v_exp_f32 v54, v54
    v_exp_f32 v55, v55
    v_cvt_pk_bf16_f32 v66, v52, v53
    v_cvt_pk_bf16_f32 v67, v54, v55
    v_exp_f32 v56, v56
    v_exp_f32 v57, v57
    v_exp_f32 v58, v58
    v_exp_f32 v59, v59
    v_mfma_f32_32x32x16_bf16 v[72:87], v[112:115], v[64:67], v[72:87]
    v_cvt_pk_bf16_f32 v68, v56, v57
    v_cvt_pk_bf16_f32 v69, v58, v59
    v_exp_f32 v60, v60
    v_exp_f32 v61, v61
    v_exp_f32 v62, v62
    v_exp_f32 v63, v63
    v_cvt_pk_bf16_f32 v70, v60, v61
    v_cvt_pk_bf16_f32 v71, v62, v63
    s_nop 1
    v_mfma_f32_32x32x16_bf16 v[72:87], v[116:119], v[68:71], v[72:87]
    s_waitcnt lgkmcnt(0)
    ds_read_b128 v[88:91], v8 offset:0
    ds_read_b64 v[92:93], v9 offset:0
    ds_read_b64_tr_b16 v[112:113], v7 offset:1536
    ds_read_b64_tr_b16 v[114:115], v7 offset:1664
    ds_read_b64_tr_b16 v[116:117], v7 offset:1792
    ds_read_b64_tr_b16 v[118:119], v7 offset:1920
    v_mfma_f32_32x32x16_bf16 v[48:63], v[96:99], v[120:123], 0
    v_exp_f32 v32, v32
    v_exp_f32 v33, v33
    v_exp_f32 v34, v34
    v_exp_f32 v35, v35
    v_mfma_f32_32x32x8_bf16 v[48:63], v[100:101], v[124:125], v[48:63]
    v_cvt_pk_bf16_f32 v64, v32, v33
    v_cvt_pk_bf16_f32 v65, v34, v35
    v_exp_f32 v36, v36
    v_exp_f32 v37, v37
    v_exp_f32 v38, v38
    v_exp_f32 v39, v39
    v_cvt_pk_bf16_f32 v66, v36, v37
    v_cvt_pk_bf16_f32 v67, v38, v39
    v_exp_f32 v40, v40
    v_exp_f32 v41, v41
    v_exp_f32 v42, v42
    v_exp_f32 v43, v43
    v_mfma_f32_32x32x16_bf16 v[72:87], v[104:107], v[64:67], v[72:87]
    v_cvt_pk_bf16_f32 v68, v40, v41
    v_cvt_pk_bf16_f32 v69, v42, v43
    v_exp_f32 v44, v44
    v_exp_f32 v45, v45
    v_exp_f32 v46, v46
    v_exp_f32 v47, v47
    v_cvt_pk_bf16_f32 v70, v44, v45
    v_cvt_pk_bf16_f32 v71, v46, v47
    s_nop 1
    v_mfma_f32_32x32x16_bf16 v[72:87], v[108:111], v[68:71], v[72:87]
    s_waitcnt lgkmcnt(0)
    ds_read_b128 v[96:99], v8 offset:512
    ds_read_b64 v[100:101], v9 offset:512
    ds_read_b64_tr_b16 v[104:105], v10 offset:0
    ds_read_b64_tr_b16 v[106:107], v10 offset:128
    ds_read_b64_tr_b16 v[108:109], v10 offset:256
    ds_read_b64_tr_b16 v[110:111], v10 offset:384
    v_mfma_f32_32x32x16_bf16 v[32:47], v[88:91], v[120:123], 0
    v_exp_f32 v48, v48
    v_exp_f32 v49, v49
    v_exp_f32 v50, v50
    v_exp_f32 v51, v51
    v_mfma_f32_32x32x8_bf16 v[32:47], v[92:93], v[124:125], v[32:47]
    v_cvt_pk_bf16_f32 v64, v48, v49
    v_cvt_pk_bf16_f32 v65, v50, v51
    v_exp_f32 v52, v52
    v_exp_f32 v53, v53
    v_exp_f32 v54, v54
    v_exp_f32 v55, v55
    v_cvt_pk_bf16_f32 v66, v52, v53
    v_cvt_pk_bf16_f32 v67, v54, v55
    v_exp_f32 v56, v56
    v_exp_f32 v57, v57
    v_exp_f32 v58, v58
    v_exp_f32 v59, v59
    v_mfma_f32_32x32x16_bf16 v[72:87], v[112:115], v[64:67], v[72:87]
    v_cvt_pk_bf16_f32 v68, v56, v57
    v_cvt_pk_bf16_f32 v69, v58, v59
    v_exp_f32 v60, v60
    v_exp_f32 v61, v61
    v_exp_f32 v62, v62
    v_exp_f32 v63, v63
    v_cvt_pk_bf16_f32 v70, v60, v61
    v_cvt_pk_bf16_f32 v71, v62, v63
    s_nop 1
    v_mfma_f32_32x32x16_bf16 v[72:87], v[116:119], v[68:71], v[72:87]
    s_mov_b32 s34, s30
    s_mov_b32 s30, s31
    s_mov_b32 s31, s32
    s_mov_b32 s32, s34
    s_add_u32 s33, s33, 1
    s_cmp_lt_u32 s33, 8
    s_cbranch_scc1 K2_LOOP
    s_branch K2_DONE
K2_SLOW:
    s_add_u32 m0, s27, s32
    s_nop 0
    buffer_load_dwordx4 v1, s[12:15], s24 offen lds
    s_add_u32 s24, s24, 2048
    s_cmp_ge_u32 s22, 4
    s_cbranch_scc1 K2_D5
    s_add_u32 m0, s28, s32
    s_nop 0
    buffer_load_dwordx4 v1, s[12:15], s25 offen lds
    s_add_u32 s25, s25, 2048
K2_D5:
    s_mul_i32 s42, s20, 53760
    s_add_u32 s42, s42, 14966784
    v_lshlrev_b32 v14, 2, v15
    v_cmp_gt_u32 vcc, 840, v15
    s_nop 1
    s_and_saveexec_b64 s[52:53], vcc
    s_cbranch_execz K2_NOKVSL
    buffer_load_dword v16, v14, s[12:15], s42 offen
    s_add_u32 s42, s42, 3360
    buffer_load_dword v17, v14, s[12:15], s42 offen
    s_add_u32 s42, s42, 3360
    buffer_load_dword v18, v14, s[12:15], s42 offen
    s_add_u32 s42, s42, 3360
    buffer_load_dword v19, v14, s[12:15], s42 offen
    s_add_u32 s42, s42, 3360
    buffer_load_dword v20, v14, s[12:15], s42 offen
    s_add_u32 s42, s42, 3360
    buffer_load_dword v21, v14, s[12:15], s42 offen
    s_add_u32 s42, s42, 3360
    buffer_load_dword v22, v14, s[12:15], s42 offen
    s_add_u32 s42, s42, 3360
    buffer_load_dword v23, v14, s[12:15], s42 offen
    s_add_u32 s42, s42, 3360
    buffer_load_dword v24, v14, s[12:15], s42 offen
    s_add_u32 s42, s42, 3360
    buffer_load_dword v25, v14, s[12:15], s42 offen
    s_add_u32 s42, s42, 3360
    buffer_load_dword v26, v14, s[12:15], s42 offen
    s_add_u32 s42, s42, 3360
    buffer_load_dword v27, v14, s[12:15], s42 offen
    s_add_u32 s42, s42, 3360
    buffer_load_dword v28, v14, s[12:15], s42 offen
    s_add_u32 s42, s42, 3360
    buffer_load_dword v29, v14, s[12:15], s42 offen
    s_add_u32 s42, s42, 3360
    buffer_load_dword v30, v14, s[12:15], s42 offen
    s_add_u32 s42, s42, 3360
    buffer_load_dword v31, v14, s[12:15], s42 offen
    s_add_u32 s42, s42, 3360
K2_NOKVSL:
    s_mov_b64 exec, s[52:53]
    s_mul_i32 s42, s20, 163840
    s_lshl_b32 s43, s21, 12
    s_add_u32 s42, s42, s43
    s_add_u32 s42, s42, 9723904
    s_add_u32 s43, s23, 0
    s_lshr_b32 s44, s43, 2
    s_and_b32 s45, s43, 3
    s_lshl_b32 s47, s44, 15
    s_lshl_b32 s45, s45, 10
    s_add_u32 s47, s47, s45
    s_add_u32 s47, s47, s42
    s_lshl_b32 s44, s43, 10
    s_add_u32 m0, s44, 3072
    s_nop 0
    buffer_load_dwordx4 v1, s[12:15], s47 offen lds
    s_cmp_ge_u32 s23, 4
    s_cbranch_scc1 K2_NOPHSL
    s_add_u32 s43, s23, 16
    s_lshr_b32 s44, s43, 2
    s_and_b32 s45, s43, 3
    s_lshl_b32 s47, s44, 15
    s_lshl_b32 s45, s45, 10
    s_add_u32 s47, s47, s45
    s_add_u32 s47, s47, s42
    s_lshl_b32 s44, s43, 10
    s_add_u32 m0, s44, 3072
    s_nop 0
    buffer_load_dwordx4 v1, s[12:15], s47 offen lds
K2_NOPHSL:
    v_add_u32 v5, s30, v2
    v_add_u32 v8, s31, v2
    v_add_u32 v6, s30, v3
    v_add_u32 v9, s31, v3
    v_add_u32 v7, s30, v4
    v_add_u32 v10, s31, v4
    s_waitcnt lgkmcnt(0)
    ds_read_b128 v[88:91], v5 offset:1024
    ds_read_b64 v[92:93], v6 offset:1024
    ds_read_b64_tr_b16 v[112:113], v7 offset:512
    ds_read_b64_tr_b16 v[114:115], v7 offset:640
    ds_read_b64_tr_b16 v[116:117], v7 offset:768
    ds_read_b64_tr_b16 v[118:119], v7 offset:896
    v_mfma_f32_32x32x16_bf16 v[48:63], v[96:99], v[120:123], 0
    v_mfma_f32_32x32x8_bf16 v[48:63], v[100:101], v[124:125], v[48:63]
    v_max3_f32 v13, v32, v33, v34
    v_max3_f32 v13, v13, v35, v36
    v_max3_f32 v13, v13, v37, v38
    v_max3_f32 v13, v13, v39, v40
    v_max3_f32 v13, v13, v41, v42
    v_max3_f32 v13, v13, v43, v44
    v_max3_f32 v13, v13, v45, v46
    v_max_f32 v13, v13, v47
    v_mov_b32 v14, v13
    s_nop 1
    v_permlane32_swap_b32 v13, v14
    v_max3_f32 v13, v13, v14, v12
    v_sub_f32 v14, v12, v13
    v_exp_f32 v14, v14
    v_mov_b32 v12, v13
    v_sub_f32 v32, v32, v13
    v_sub_f32 v33, v33, v13
    v_sub_f32 v34, v34, v13
    v_sub_f32 v35, v35, v13
    v_sub_f32 v36, v36, v13
    v_sub_f32 v37, v37, v13
    v_sub_f32 v38, v38, v13
    v_sub_f32 v39, v39, v13
    v_sub_f32 v40, v40, v13
    v_sub_f32 v41, v41, v13
    v_sub_f32 v42, v42, v13
    v_sub_f32 v43, v43, v13
    v_sub_f32 v44, v44, v13
    v_sub_f32 v45, v45, v13
    v_sub_f32 v46, v46, v13
    v_sub_f32 v47, v47, v13
    v_exp_f32 v32, v32
    v_exp_f32 v33, v33
    v_exp_f32 v34, v34
    v_exp_f32 v35, v35
    v_exp_f32 v36, v36
    v_exp_f32 v37, v37
    v_exp_f32 v38, v38
    v_exp_f32 v39, v39
    v_exp_f32 v40, v40
    v_exp_f32 v41, v41
    v_exp_f32 v42, v42
    v_exp_f32 v43, v43
    v_exp_f32 v44, v44
    v_exp_f32 v45, v45
    v_exp_f32 v46, v46
    v_exp_f32 v47, v47
    v_cvt_pk_bf16_f32 v64, v32, v33
    v_cvt_pk_bf16_f32 v65, v34, v35
    v_cvt_pk_bf16_f32 v66, v36, v37
    v_cvt_pk_bf16_f32 v67, v38, v39
    v_cvt_pk_bf16_f32 v68, v40, v41
    v_cvt_pk_bf16_f32 v69, v42, v43
    v_cvt_pk_bf16_f32 v70, v44, v45
    v_cvt_pk_bf16_f32 v71, v46, v47
    v_mul_f32 v72, v14, v72
    v_mul_f32 v73, v14, v73
    v_mul_f32 v74, v14, v74
    v_mul_f32 v75, v14, v75
    v_mul_f32 v76, v14, v76
    v_mul_f32 v77, v14, v77
    v_mul_f32 v78, v14, v78
    v_mul_f32 v79, v14, v79
    v_mul_f32 v80, v14, v80
    v_mul_f32 v81, v14, v81
    v_mul_f32 v82, v14, v82
    v_mul_f32 v83, v14, v83
    v_mul_f32 v84, v14, v84
    v_mul_f32 v85, v14, v85
    v_mul_f32 v86, v14, v86
    v_mul_f32 v87, v14, v87
    s_nop 1
    v_mfma_f32_32x32x16_bf16 v[72:87], v[104:107], v[64:67], v[72:87]
    v_mfma_f32_32x32x16_bf16 v[72:87], v[108:111], v[68:71], v[72:87]
    s_waitcnt lgkmcnt(0)
    ds_read_b128 v[96:99], v5 offset:1536
    ds_read_b64 v[100:101], v6 offset:1536
    ds_read_b64_tr_b16 v[104:105], v7 offset:1024
    ds_read_b64_tr_b16 v[106:107], v7 offset:1152
    ds_read_b64_tr_b16 v[108:109], v7 offset:1280
    ds_read_b64_tr_b16 v[110:111], v7 offset:1408
    v_mfma_f32_32x32x16_bf16 v[32:47], v[88:91], v[120:123], 0
    v_mfma_f32_32x32x8_bf16 v[32:47], v[92:93], v[124:125], v[32:47]
    v_max3_f32 v13, v48, v49, v50
    v_max3_f32 v13, v13, v51, v52
    v_max3_f32 v13, v13, v53, v54
    v_max3_f32 v13, v13, v55, v56
    v_max3_f32 v13, v13, v57, v58
    v_max3_f32 v13, v13, v59, v60
    v_max3_f32 v13, v13, v61, v62
    v_max_f32 v13, v13, v63
    v_mov_b32 v14, v13
    s_nop 1
    v_permlane32_swap_b32 v13, v14
    v_max3_f32 v13, v13, v14, v12
    v_sub_f32 v14, v12, v13
    v_exp_f32 v14, v14
    v_mov_b32 v12, v13
    v_sub_f32 v48, v48, v13
    v_sub_f32 v49, v49, v13
    v_sub_f32 v50, v50, v13
    v_sub_f32 v51, v51, v13
    v_sub_f32 v52, v52, v13
    v_sub_f32 v53, v53, v13
    v_sub_f32 v54, v54, v13
    v_sub_f32 v55, v55, v13
    v_sub_f32 v56, v56, v13
    v_sub_f32 v57, v57, v13
    v_sub_f32 v58, v58, v13
    v_sub_f32 v59, v59, v13
    v_sub_f32 v60, v60, v13
    v_sub_f32 v61, v61, v13
    v_sub_f32 v62, v62, v13
    v_sub_f32 v63, v63, v13
    v_exp_f32 v48, v48
    v_exp_f32 v49, v49
    v_exp_f32 v50, v50
    v_exp_f32 v51, v51
    v_exp_f32 v52, v52
    v_exp_f32 v53, v53
    v_exp_f32 v54, v54
    v_exp_f32 v55, v55
    v_exp_f32 v56, v56
    v_exp_f32 v57, v57
    v_exp_f32 v58, v58
    v_exp_f32 v59, v59
    v_exp_f32 v60, v60
    v_exp_f32 v61, v61
    v_exp_f32 v62, v62
    v_exp_f32 v63, v63
    v_cvt_pk_bf16_f32 v64, v48, v49
    v_cvt_pk_bf16_f32 v65, v50, v51
    v_cvt_pk_bf16_f32 v66, v52, v53
    v_cvt_pk_bf16_f32 v67, v54, v55
    v_cvt_pk_bf16_f32 v68, v56, v57
    v_cvt_pk_bf16_f32 v69, v58, v59
    v_cvt_pk_bf16_f32 v70, v60, v61
    v_cvt_pk_bf16_f32 v71, v62, v63
    v_mul_f32 v72, v14, v72
    v_mul_f32 v73, v14, v73
    v_mul_f32 v74, v14, v74
    v_mul_f32 v75, v14, v75
    v_mul_f32 v76, v14, v76
    v_mul_f32 v77, v14, v77
    v_mul_f32 v78, v14, v78
    v_mul_f32 v79, v14, v79
    v_mul_f32 v80, v14, v80
    v_mul_f32 v81, v14, v81
    v_mul_f32 v82, v14, v82
    v_mul_f32 v83, v14, v83
    v_mul_f32 v84, v14, v84
    v_mul_f32 v85, v14, v85
    v_mul_f32 v86, v14, v86
    v_mul_f32 v87, v14, v87
    s_nop 1
    v_mfma_f32_32x32x16_bf16 v[72:87], v[112:115], v[64:67], v[72:87]
    v_mfma_f32_32x32x16_bf16 v[72:87], v[116:119], v[68:71], v[72:87]
    s_waitcnt lgkmcnt(0)
    ds_read_b128 v[88:91], v8 offset:0
    ds_read_b64 v[92:93], v9 offset:0
    ds_read_b64_tr_b16 v[112:113], v7 offset:1536
    ds_read_b64_tr_b16 v[114:115], v7 offset:1664
    ds_read_b64_tr_b16 v[116:117], v7 offset:1792
    ds_read_b64_tr_b16 v[118:119], v7 offset:1920
    v_mfma_f32_32x32x16_bf16 v[48:63], v[96:99], v[120:123], 0
    v_mfma_f32_32x32x8_bf16 v[48:63], v[100:101], v[124:125], v[48:63]
    v_max3_f32 v13, v32, v33, v34
    v_max3_f32 v13, v13, v35, v36
    v_max3_f32 v13, v13, v37, v38
    v_max3_f32 v13, v13, v39, v40
    v_max3_f32 v13, v13, v41, v42
    v_max3_f32 v13, v13, v43, v44
    v_max3_f32 v13, v13, v45, v46
    v_max_f32 v13, v13, v47
    v_mov_b32 v14, v13
    s_nop 1
    v_permlane32_swap_b32 v13, v14
    v_max3_f32 v13, v13, v14, v12
    v_sub_f32 v14, v12, v13
    v_exp_f32 v14, v14
    v_mov_b32 v12, v13
    v_sub_f32 v32, v32, v13
    v_sub_f32 v33, v33, v13
    v_sub_f32 v34, v34, v13
    v_sub_f32 v35, v35, v13
    v_sub_f32 v36, v36, v13
    v_sub_f32 v37, v37, v13
    v_sub_f32 v38, v38, v13
    v_sub_f32 v39, v39, v13
    v_sub_f32 v40, v40, v13
    v_sub_f32 v41, v41, v13
    v_sub_f32 v42, v42, v13
    v_sub_f32 v43, v43, v13
    v_sub_f32 v44, v44, v13
    v_sub_f32 v45, v45, v13
    v_sub_f32 v46, v46, v13
    v_sub_f32 v47, v47, v13
    v_exp_f32 v32, v32
    v_exp_f32 v33, v33
    v_exp_f32 v34, v34
    v_exp_f32 v35, v35
    v_exp_f32 v36, v36
    v_exp_f32 v37, v37
    v_exp_f32 v38, v38
    v_exp_f32 v39, v39
    v_exp_f32 v40, v40
    v_exp_f32 v41, v41
    v_exp_f32 v42, v42
    v_exp_f32 v43, v43
    v_exp_f32 v44, v44
    v_exp_f32 v45, v45
    v_exp_f32 v46, v46
    v_exp_f32 v47, v47
    v_cvt_pk_bf16_f32 v64, v32, v33
    v_cvt_pk_bf16_f32 v65, v34, v35
    v_cvt_pk_bf16_f32 v66, v36, v37
    v_cvt_pk_bf16_f32 v67, v38, v39
    v_cvt_pk_bf16_f32 v68, v40, v41
    v_cvt_pk_bf16_f32 v69, v42, v43
    v_cvt_pk_bf16_f32 v70, v44, v45
    v_cvt_pk_bf16_f32 v71, v46, v47
    v_mul_f32 v72, v14, v72
    v_mul_f32 v73, v14, v73
    v_mul_f32 v74, v14, v74
    v_mul_f32 v75, v14, v75
    v_mul_f32 v76, v14, v76
    v_mul_f32 v77, v14, v77
    v_mul_f32 v78, v14, v78
    v_mul_f32 v79, v14, v79
    v_mul_f32 v80, v14, v80
    v_mul_f32 v81, v14, v81
    v_mul_f32 v82, v14, v82
    v_mul_f32 v83, v14, v83
    v_mul_f32 v84, v14, v84
    v_mul_f32 v85, v14, v85
    v_mul_f32 v86, v14, v86
    v_mul_f32 v87, v14, v87
    s_nop 1
    v_mfma_f32_32x32x16_bf16 v[72:87], v[104:107], v[64:67], v[72:87]
    v_mfma_f32_32x32x16_bf16 v[72:87], v[108:111], v[68:71], v[72:87]
    s_waitcnt lgkmcnt(0)
    ds_read_b128 v[96:99], v8 offset:512
    ds_read_b64 v[100:101], v9 offset:512
    ds_read_b64_tr_b16 v[104:105], v10 offset:0
    ds_read_b64_tr_b16 v[106:107], v10 offset:128
    ds_read_b64_tr_b16 v[108:109], v10 offset:256
    ds_read_b64_tr_b16 v[110:111], v10 offset:384
    v_mfma_f32_32x32x16_bf16 v[32:47], v[88:91], v[120:123], 0
    v_mfma_f32_32x32x8_bf16 v[32:47], v[92:93], v[124:125], v[32:47]
    v_max3_f32 v13, v48, v49, v50
    v_max3_f32 v13, v13, v51, v52
    v_max3_f32 v13, v13, v53, v54
    v_max3_f32 v13, v13, v55, v56
    v_max3_f32 v13, v13, v57, v58
    v_max3_f32 v13, v13, v59, v60
    v_max3_f32 v13, v13, v61, v62
    v_max_f32 v13, v13, v63
    v_mov_b32 v14, v13
    s_nop 1
    v_permlane32_swap_b32 v13, v14
    v_max3_f32 v13, v13, v14, v12
    v_sub_f32 v14, v12, v13
    v_exp_f32 v14, v14
    v_mov_b32 v12, v13
    v_sub_f32 v48, v48, v13
    v_sub_f32 v49, v49, v13
    v_sub_f32 v50, v50, v13
    v_sub_f32 v51, v51, v13
    v_sub_f32 v52, v52, v13
    v_sub_f32 v53, v53, v13
    v_sub_f32 v54, v54, v13
    v_sub_f32 v55, v55, v13
    v_sub_f32 v56, v56, v13
    v_sub_f32 v57, v57, v13
    v_sub_f32 v58, v58, v13
    v_sub_f32 v59, v59, v13
    v_sub_f32 v60, v60, v13
    v_sub_f32 v61, v61, v13
    v_sub_f32 v62, v62, v13
    v_sub_f32 v63, v63, v13
    v_exp_f32 v48, v48
    v_exp_f32 v49, v49
    v_exp_f32 v50, v50
    v_exp_f32 v51, v51
    v_exp_f32 v52, v52
    v_exp_f32 v53, v53
    v_exp_f32 v54, v54
    v_exp_f32 v55, v55
    v_exp_f32 v56, v56
    v_exp_f32 v57, v57
    v_exp_f32 v58, v58
    v_exp_f32 v59, v59
    v_exp_f32 v60, v60
    v_exp_f32 v61, v61
    v_exp_f32 v62, v62
    v_exp_f32 v63, v63
    v_cvt_pk_bf16_f32 v64, v48, v49
    v_cvt_pk_bf16_f32 v65, v50, v51
    v_cvt_pk_bf16_f32 v66, v52, v53
    v_cvt_pk_bf16_f32 v67, v54, v55
    v_cvt_pk_bf16_f32 v68, v56, v57
    v_cvt_pk_bf16_f32 v69, v58, v59
    v_cvt_pk_bf16_f32 v70, v60, v61
    v_cvt_pk_bf16_f32 v71, v62, v63
    v_mul_f32 v72, v14, v72
    v_mul_f32 v73, v14, v73
    v_mul_f32 v74, v14, v74
    v_mul_f32 v75, v14, v75
    v_mul_f32 v76, v14, v76
    v_mul_f32 v77, v14, v77
    v_mul_f32 v78, v14, v78
    v_mul_f32 v79, v14, v79
    v_mul_f32 v80, v14, v80
    v_mul_f32 v81, v14, v81
    v_mul_f32 v82, v14, v82
    v_mul_f32 v83, v14, v83
    v_mul_f32 v84, v14, v84
    v_mul_f32 v85, v14, v85
    v_mul_f32 v86, v14, v86
    v_mul_f32 v87, v14, v87
    s_nop 1
    v_mfma_f32_32x32x16_bf16 v[72:87], v[112:115], v[64:67], v[72:87]
    v_mfma_f32_32x32x16_bf16 v[72:87], v[116:119], v[68:71], v[72:87]
    s_mov_b32 s34, s30
    s_mov_b32 s30, s31
    s_mov_b32 s31, s32
    s_mov_b32 s32, s34
    s_add_u32 s33, s33, 1
    s_waitcnt vmcnt(0)
    v_add_f32 v16, v16, v17
    v_add_f32 v16, v16, v18
    v_add_f32 v16, v16, v19
    v_add_f32 v16, v16, v20
    v_add_f32 v16, v16, v21
    v_add_f32 v16, v16, v22
    v_add_f32 v16, v16, v23
    v_add_f32 v16, v16, v24
    v_add_f32 v16, v16, v25
    v_add_f32 v16, v16, v26
    v_add_f32 v16, v16, v27
    v_add_f32 v16, v16, v28
    v_add_f32 v16, v16, v29
    v_add_f32 v16, v16, v30
    v_add_f32 v16, v16, v31
    v_cvt_pk_bf16_f32 v16, v16, v16
    v_lshlrev_b32 v14, 1, v15
    v_cmp_gt_u32 vcc, 840, v15
    s_nop 1
    s_and_saveexec_b64 s[52:53], vcc
    ds_write_b16 v14, v16 offset:0
    s_mov_b64 exec, s[52:53]
    s_waitcnt lgkmcnt(0)
    s_barrier
    s_add_u32 m0, s27, s32
    s_nop 0
    buffer_load_dwordx4 v1, s[12:15], s24 offen lds
    s_add_u32 s24, s24, 2048
    s_cmp_ge_u32 s22, 4
    s_cbranch_scc1 K2_D6
    s_add_u32 m0, s28, s32
    s_nop 0
    buffer_load_dwordx4 v1, s[12:15], s25 offen lds
    s_add_u32 s25, s25, 2048
K2_D6:
    v_add_u32 v5, s30, v2
    v_add_u32 v8, s31, v2
    v_add_u32 v6, s30, v3
    v_add_u32 v9, s31, v3
    v_add_u32 v7, s30, v4
    v_add_u32 v10, s31, v4
    s_waitcnt lgkmcnt(0)
    ds_read_b128 v[88:91], v5 offset:1024
    ds_read_b64 v[92:93], v6 offset:1024
    ds_read_b64_tr_b16 v[112:113], v7 offset:512
    ds_read_b64_tr_b16 v[114:115], v7 offset:640
    ds_read_b64_tr_b16 v[116:117], v7 offset:768
    ds_read_b64_tr_b16 v[118:119], v7 offset:896
    v_mfma_f32_32x32x16_bf16 v[48:63], v[96:99], v[120:123], 0
    v_mfma_f32_32x32x8_bf16 v[48:63], v[100:101], v[124:125], v[48:63]
    v_max3_f32 v13, v32, v33, v34
    v_max3_f32 v13, v13, v35, v36
    v_max3_f32 v13, v13, v37, v38
    v_max3_f32 v13, v13, v39, v40
    v_max3_f32 v13, v13, v41, v42
    v_max3_f32 v13, v13, v43, v44
    v_max3_f32 v13, v13, v45, v46
    v_max_f32 v13, v13, v47
    v_mov_b32 v14, v13
    s_nop 1
    v_permlane32_swap_b32 v13, v14
    v_max3_f32 v13, v13, v14, v12
    v_sub_f32 v14, v12, v13
    v_exp_f32 v14, v14
    v_mov_b32 v12, v13
    v_sub_f32 v32, v32, v13
    v_sub_f32 v33, v33, v13
    v_sub_f32 v34, v34, v13
    v_sub_f32 v35, v35, v13
    v_sub_f32 v36, v36, v13
    v_sub_f32 v37, v37, v13
    v_sub_f32 v38, v38, v13
    v_sub_f32 v39, v39, v13
    v_sub_f32 v40, v40, v13
    v_sub_f32 v41, v41, v13
    v_sub_f32 v42, v42, v13
    v_sub_f32 v43, v43, v13
    v_sub_f32 v44, v44, v13
    v_sub_f32 v45, v45, v13
    v_sub_f32 v46, v46, v13
    v_sub_f32 v47, v47, v13
    v_exp_f32 v32, v32
    v_exp_f32 v33, v33
    v_exp_f32 v34, v34
    v_exp_f32 v35, v35
    v_exp_f32 v36, v36
    v_exp_f32 v37, v37
    v_exp_f32 v38, v38
    v_exp_f32 v39, v39
    v_exp_f32 v40, v40
    v_exp_f32 v41, v41
    v_exp_f32 v42, v42
    v_exp_f32 v43, v43
    v_exp_f32 v44, v44
    v_exp_f32 v45, v45
    v_exp_f32 v46, v46
    v_exp_f32 v47, v47
    v_cvt_pk_bf16_f32 v64, v32, v33
    v_cvt_pk_bf16_f32 v65, v34, v35
    v_cvt_pk_bf16_f32 v66, v36, v37
    v_cvt_pk_bf16_f32 v67, v38, v39
    v_cvt_pk_bf16_f32 v68, v40, v41
    v_cvt_pk_bf16_f32 v69, v42, v43
    v_cvt_pk_bf16_f32 v70, v44, v45
    v_cvt_pk_bf16_f32 v71, v46, v47
    v_mul_f32 v72, v14, v72
    v_mul_f32 v73, v14, v73
    v_mul_f32 v74, v14, v74
    v_mul_f32 v75, v14, v75
    v_mul_f32 v76, v14, v76
    v_mul_f32 v77, v14, v77
    v_mul_f32 v78, v14, v78
    v_mul_f32 v79, v14, v79
    v_mul_f32 v80, v14, v80
    v_mul_f32 v81, v14, v81
    v_mul_f32 v82, v14, v82
    v_mul_f32 v83, v14, v83
    v_mul_f32 v84, v14, v84
    v_mul_f32 v85, v14, v85
    v_mul_f32 v86, v14, v86
    v_mul_f32 v87, v14, v87
    s_nop 1
    v_mfma_f32_32x32x16_bf16 v[72:87], v[104:107], v[64:67], v[72:87]
    v_mfma_f32_32x32x16_bf16 v[72:87], v[108:111], v[68:71], v[72:87]
    s_waitcnt lgkmcnt(0)
    ds_read_b128 v[96:99], v5 offset:1536
    ds_read_b64 v[100:101], v6 offset:1536
    ds_read_b64_tr_b16 v[104:105], v7 offset:1024
    ds_read_b64_tr_b16 v[106:107], v7 offset:1152
    ds_read_b64_tr_b16 v[108:109], v7 offset:1280
    ds_read_b64_tr_b16 v[110:111], v7 offset:1408
    v_mfma_f32_32x32x16_bf16 v[32:47], v[88:91], v[120:123], 0
    v_mfma_f32_32x32x8_bf16 v[32:47], v[92:93], v[124:125], v[32:47]
    v_max3_f32 v13, v48, v49, v50
    v_max3_f32 v13, v13, v51, v52
    v_max3_f32 v13, v13, v53, v54
    v_max3_f32 v13, v13, v55, v56
    v_max3_f32 v13, v13, v57, v58
    v_max3_f32 v13, v13, v59, v60
    v_max3_f32 v13, v13, v61, v62
    v_max_f32 v13, v13, v63
    v_mov_b32 v14, v13
    s_nop 1
    v_permlane32_swap_b32 v13, v14
    v_max3_f32 v13, v13, v14, v12
    v_sub_f32 v14, v12, v13
    v_exp_f32 v14, v14
    v_mov_b32 v12, v13
    v_sub_f32 v48, v48, v13
    v_sub_f32 v49, v49, v13
    v_sub_f32 v50, v50, v13
    v_sub_f32 v51, v51, v13
    v_sub_f32 v52, v52, v13
    v_sub_f32 v53, v53, v13
    v_sub_f32 v54, v54, v13
    v_sub_f32 v55, v55, v13
    v_sub_f32 v56, v56, v13
    v_sub_f32 v57, v57, v13
    v_sub_f32 v58, v58, v13
    v_sub_f32 v59, v59, v13
    v_sub_f32 v60, v60, v13
    v_sub_f32 v61, v61, v13
    v_sub_f32 v62, v62, v13
    v_sub_f32 v63, v63, v13
    v_exp_f32 v48, v48
    v_exp_f32 v49, v49
    v_exp_f32 v50, v50
    v_exp_f32 v51, v51
    v_exp_f32 v52, v52
    v_exp_f32 v53, v53
    v_exp_f32 v54, v54
    v_exp_f32 v55, v55
    v_exp_f32 v56, v56
    v_exp_f32 v57, v57
    v_exp_f32 v58, v58
    v_exp_f32 v59, v59
    v_exp_f32 v60, v60
    v_exp_f32 v61, v61
    v_exp_f32 v62, v62
    v_exp_f32 v63, v63
    v_cvt_pk_bf16_f32 v64, v48, v49
    v_cvt_pk_bf16_f32 v65, v50, v51
    v_cvt_pk_bf16_f32 v66, v52, v53
    v_cvt_pk_bf16_f32 v67, v54, v55
    v_cvt_pk_bf16_f32 v68, v56, v57
    v_cvt_pk_bf16_f32 v69, v58, v59
    v_cvt_pk_bf16_f32 v70, v60, v61
    v_cvt_pk_bf16_f32 v71, v62, v63
    v_mul_f32 v72, v14, v72
    v_mul_f32 v73, v14, v73
    v_mul_f32 v74, v14, v74
    v_mul_f32 v75, v14, v75
    v_mul_f32 v76, v14, v76
    v_mul_f32 v77, v14, v77
    v_mul_f32 v78, v14, v78
    v_mul_f32 v79, v14, v79
    v_mul_f32 v80, v14, v80
    v_mul_f32 v81, v14, v81
    v_mul_f32 v82, v14, v82
    v_mul_f32 v83, v14, v83
    v_mul_f32 v84, v14, v84
    v_mul_f32 v85, v14, v85
    v_mul_f32 v86, v14, v86
    v_mul_f32 v87, v14, v87
    s_nop 1
    v_mfma_f32_32x32x16_bf16 v[72:87], v[112:115], v[64:67], v[72:87]
    v_mfma_f32_32x32x16_bf16 v[72:87], v[116:119], v[68:71], v[72:87]
    s_waitcnt lgkmcnt(0)
    ds_read_b128 v[88:91], v8 offset:0
    ds_read_b64 v[92:93], v9 offset:0
    ds_read_b64_tr_b16 v[112:113], v7 offset:1536
    ds_read_b64_tr_b16 v[114:115], v7 offset:1664
    ds_read_b64_tr_b16 v[116:117], v7 offset:1792
    ds_read_b64_tr_b16 v[118:119], v7 offset:1920
    v_mfma_f32_32x32x16_bf16 v[48:63], v[96:99], v[120:123], 0
    v_mfma_f32_32x32x8_bf16 v[48:63], v[100:101], v[124:125], v[48:63]
    v_max3_f32 v13, v32, v33, v34
    v_max3_f32 v13, v13, v35, v36
    v_max3_f32 v13, v13, v37, v38
    v_max3_f32 v13, v13, v39, v40
    v_max3_f32 v13, v13, v41, v42
    v_max3_f32 v13, v13, v43, v44
    v_max3_f32 v13, v13, v45, v46
    v_max_f32 v13, v13, v47
    v_mov_b32 v14, v13
    s_nop 1
    v_permlane32_swap_b32 v13, v14
    v_max3_f32 v13, v13, v14, v12
    v_sub_f32 v14, v12, v13
    v_exp_f32 v14, v14
    v_mov_b32 v12, v13
    v_sub_f32 v32, v32, v13
    v_sub_f32 v33, v33, v13
    v_sub_f32 v34, v34, v13
    v_sub_f32 v35, v35, v13
    v_sub_f32 v36, v36, v13
    v_sub_f32 v37, v37, v13
    v_sub_f32 v38, v38, v13
    v_sub_f32 v39, v39, v13
    v_sub_f32 v40, v40, v13
    v_sub_f32 v41, v41, v13
    v_sub_f32 v42, v42, v13
    v_sub_f32 v43, v43, v13
    v_sub_f32 v44, v44, v13
    v_sub_f32 v45, v45, v13
    v_sub_f32 v46, v46, v13
    v_sub_f32 v47, v47, v13
    v_exp_f32 v32, v32
    v_exp_f32 v33, v33
    v_exp_f32 v34, v34
    v_exp_f32 v35, v35
    v_exp_f32 v36, v36
    v_exp_f32 v37, v37
    v_exp_f32 v38, v38
    v_exp_f32 v39, v39
    v_exp_f32 v40, v40
    v_exp_f32 v41, v41
    v_exp_f32 v42, v42
    v_exp_f32 v43, v43
    v_exp_f32 v44, v44
    v_exp_f32 v45, v45
    v_exp_f32 v46, v46
    v_exp_f32 v47, v47
    v_cvt_pk_bf16_f32 v64, v32, v33
    v_cvt_pk_bf16_f32 v65, v34, v35
    v_cvt_pk_bf16_f32 v66, v36, v37
    v_cvt_pk_bf16_f32 v67, v38, v39
    v_cvt_pk_bf16_f32 v68, v40, v41
    v_cvt_pk_bf16_f32 v69, v42, v43
    v_cvt_pk_bf16_f32 v70, v44, v45
    v_cvt_pk_bf16_f32 v71, v46, v47
    v_mul_f32 v72, v14, v72
    v_mul_f32 v73, v14, v73
    v_mul_f32 v74, v14, v74
    v_mul_f32 v75, v14, v75
    v_mul_f32 v76, v14, v76
    v_mul_f32 v77, v14, v77
    v_mul_f32 v78, v14, v78
    v_mul_f32 v79, v14, v79
    v_mul_f32 v80, v14, v80
    v_mul_f32 v81, v14, v81
    v_mul_f32 v82, v14, v82
    v_mul_f32 v83, v14, v83
    v_mul_f32 v84, v14, v84
    v_mul_f32 v85, v14, v85
    v_mul_f32 v86, v14, v86
    v_mul_f32 v87, v14, v87
    s_nop 1
    v_mfma_f32_32x32x16_bf16 v[72:87], v[104:107], v[64:67], v[72:87]
    v_mfma_f32_32x32x16_bf16 v[72:87], v[108:111], v[68:71], v[72:87]
    s_waitcnt lgkmcnt(0)
    ds_read_b128 v[96:99], v8 offset:512
    ds_read_b64 v[100:101], v9 offset:512
    ds_read_b64_tr_b16 v[104:105], v10 offset:0
    ds_read_b64_tr_b16 v[106:107], v10 offset:128
    ds_read_b64_tr_b16 v[108:109], v10 offset:256
    ds_read_b64_tr_b16 v[110:111], v10 offset:384
    v_mfma_f32_32x32x16_bf16 v[32:47], v[88:91], v[120:123], 0
    v_mfma_f32_32x32x8_bf16 v[32:47], v[92:93], v[124:125], v[32:47]
    v_max3_f32 v13, v48, v49, v50
    v_max3_f32 v13, v13, v51, v52
    v_max3_f32 v13, v13, v53, v54
    v_max3_f32 v13, v13, v55, v56
    v_max3_f32 v13, v13, v57, v58
    v_max3_f32 v13, v13, v59, v60
    v_max3_f32 v13, v13, v61, v62
    v_max_f32 v13, v13, v63
    v_mov_b32 v14, v13
    s_nop 1
    v_permlane32_swap_b32 v13, v14
    v_max3_f32 v13, v13, v14, v12
    v_sub_f32 v14, v12, v13
    v_exp_f32 v14, v14
    v_mov_b32 v12, v13
    v_sub_f32 v48, v48, v13
    v_sub_f32 v49, v49, v13
    v_sub_f32 v50, v50, v13
    v_sub_f32 v51, v51, v13
    v_sub_f32 v52, v52, v13
    v_sub_f32 v53, v53, v13
    v_sub_f32 v54, v54, v13
    v_sub_f32 v55, v55, v13
    v_sub_f32 v56, v56, v13
    v_sub_f32 v57, v57, v13
    v_sub_f32 v58, v58, v13
    v_sub_f32 v59, v59, v13
    v_sub_f32 v60, v60, v13
    v_sub_f32 v61, v61, v13
    v_sub_f32 v62, v62, v13
    v_sub_f32 v63, v63, v13
    v_exp_f32 v48, v48
    v_exp_f32 v49, v49
    v_exp_f32 v50, v50
    v_exp_f32 v51, v51
    v_exp_f32 v52, v52
    v_exp_f32 v53, v53
    v_exp_f32 v54, v54
    v_exp_f32 v55, v55
    v_exp_f32 v56, v56
    v_exp_f32 v57, v57
    v_exp_f32 v58, v58
    v_exp_f32 v59, v59
    v_exp_f32 v60, v60
    v_exp_f32 v61, v61
    v_exp_f32 v62, v62
    v_exp_f32 v63, v63
    v_cvt_pk_bf16_f32 v64, v48, v49
    v_cvt_pk_bf16_f32 v65, v50, v51
    v_cvt_pk_bf16_f32 v66, v52, v53
    v_cvt_pk_bf16_f32 v67, v54, v55
    v_cvt_pk_bf16_f32 v68, v56, v57
    v_cvt_pk_bf16_f32 v69, v58, v59
    v_cvt_pk_bf16_f32 v70, v60, v61
    v_cvt_pk_bf16_f32 v71, v62, v63
    v_mul_f32 v72, v14, v72
    v_mul_f32 v73, v14, v73
    v_mul_f32 v74, v14, v74
    v_mul_f32 v75, v14, v75
    v_mul_f32 v76, v14, v76
    v_mul_f32 v77, v14, v77
    v_mul_f32 v78, v14, v78
    v_mul_f32 v79, v14, v79
    v_mul_f32 v80, v14, v80
    v_mul_f32 v81, v14, v81
    v_mul_f32 v82, v14, v82
    v_mul_f32 v83, v14, v83
    v_mul_f32 v84, v14, v84
    v_mul_f32 v85, v14, v85
    v_mul_f32 v86, v14, v86
    v_mul_f32 v87, v14, v87
    s_nop 1
    v_mfma_f32_32x32x16_bf16 v[72:87], v[112:115], v[64:67], v[72:87]
    v_mfma_f32_32x32x16_bf16 v[72:87], v[116:119], v[68:71], v[72:87]
    s_mov_b32 s34, s30
    s_mov_b32 s30, s31
    s_mov_b32 s31, s32
    s_mov_b32 s32, s34
    s_add_u32 s33, s33, 1
K2_LOOPSL:
    s_waitcnt vmcnt(0)
    s_barrier
    s_cmp_ge_u32 s33, 6
    s_cbranch_scc1 K2_NODMASL
    s_add_u32 m0, s27, s32
    s_nop 0
    buffer_load_dwordx4 v1, s[12:15], s24 offen lds
    s_add_u32 s24, s24, 2048
    s_cmp_ge_u32 s22, 4
    s_cbranch_scc1 K2_D7
    s_add_u32 m0, s28, s32
    s_nop 0
    buffer_load_dwordx4 v1, s[12:15], s25 offen lds
    s_add_u32 s25, s25, 2048
K2_D7:
K2_NODMASL:
    v_add_u32 v5, s30, v2
    v_add_u32 v8, s31, v2
    v_add_u32 v6, s30, v3
    v_add_u32 v9, s31, v3
    v_add_u32 v7, s30, v4
    v_add_u32 v10, s31, v4
    s_waitcnt lgkmcnt(0)
    ds_read_b128 v[88:91], v5 offset:1024
    ds_read_b64 v[92:93], v6 offset:1024
    ds_read_b64_tr_b16 v[112:113], v7 offset:512
    ds_read_b64_tr_b16 v[114:115], v7 offset:640
    ds_read_b64_tr_b16 v[116:117], v7 offset:768
    ds_read_b64_tr_b16 v[118:119], v7 offset:896
    v_mfma_f32_32x32x16_bf16 v[48:63], v[96:99], v[120:123], 0
    v_mfma_f32_32x32x8_bf16 v[48:63], v[100:101], v[124:125], v[48:63]
    v_max3_f32 v13, v32, v33, v34
    v_max3_f32 v13, v13, v35, v36
    v_max3_f32 v13, v13, v37, v38
    v_max3_f32 v13, v13, v39, v40
    v_max3_f32 v13, v13, v41, v42
    v_max3_f32 v13, v13, v43, v44
    v_max3_f32 v13, v13, v45, v46
    v_max_f32 v13, v13, v47
    v_mov_b32 v14, v13
    s_nop 1
    v_permlane32_swap_b32 v13, v14
    v_max3_f32 v13, v13, v14, v12
    v_sub_f32 v14, v12, v13
    v_exp_f32 v14, v14
    v_mov_b32 v12, v13
    v_sub_f32 v32, v32, v13
    v_sub_f32 v33, v33, v13
    v_sub_f32 v34, v34, v13
    v_sub_f32 v35, v35, v13
    v_sub_f32 v36, v36, v13
    v_sub_f32 v37, v37, v13
    v_sub_f32 v38, v38, v13
    v_sub_f32 v39, v39, v13
    v_sub_f32 v40, v40, v13
    v_sub_f32 v41, v41, v13
    v_sub_f32 v42, v42, v13
    v_sub_f32 v43, v43, v13
    v_sub_f32 v44, v44, v13
    v_sub_f32 v45, v45, v13
    v_sub_f32 v46, v46, v13
    v_sub_f32 v47, v47, v13
    v_exp_f32 v32, v32
    v_exp_f32 v33, v33
    v_exp_f32 v34, v34
    v_exp_f32 v35, v35
    v_exp_f32 v36, v36
    v_exp_f32 v37, v37
    v_exp_f32 v38, v38
    v_exp_f32 v39, v39
    v_exp_f32 v40, v40
    v_exp_f32 v41, v41
    v_exp_f32 v42, v42
    v_exp_f32 v43, v43
    v_exp_f32 v44, v44
    v_exp_f32 v45, v45
    v_exp_f32 v46, v46
    v_exp_f32 v47, v47
    v_cvt_pk_bf16_f32 v64, v32, v33
    v_cvt_pk_bf16_f32 v65, v34, v35
    v_cvt_pk_bf16_f32 v66, v36, v37
    v_cvt_pk_bf16_f32 v67, v38, v39
    v_cvt_pk_bf16_f32 v68, v40, v41
    v_cvt_pk_bf16_f32 v69, v42, v43
    v_cvt_pk_bf16_f32 v70, v44, v45
    v_cvt_pk_bf16_f32 v71, v46, v47
    v_mul_f32 v72, v14, v72
    v_mul_f32 v73, v14, v73
    v_mul_f32 v74, v14, v74
    v_mul_f32 v75, v14, v75
    v_mul_f32 v76, v14, v76
    v_mul_f32 v77, v14, v77
    v_mul_f32 v78, v14, v78
    v_mul_f32 v79, v14, v79
    v_mul_f32 v80, v14, v80
    v_mul_f32 v81, v14, v81
    v_mul_f32 v82, v14, v82
    v_mul_f32 v83, v14, v83
    v_mul_f32 v84, v14, v84
    v_mul_f32 v85, v14, v85
    v_mul_f32 v86, v14, v86
    v_mul_f32 v87, v14, v87
    s_nop 1
    v_mfma_f32_32x32x16_bf16 v[72:87], v[104:107], v[64:67], v[72:87]
    v_mfma_f32_32x32x16_bf16 v[72:87], v[108:111], v[68:71], v[72:87]
    s_waitcnt lgkmcnt(0)
    ds_read_b128 v[96:99], v5 offset:1536
    ds_read_b64 v[100:101], v6 offset:1536
    ds_read_b64_tr_b16 v[104:105], v7 offset:1024
    ds_read_b64_tr_b16 v[106:107], v7 offset:1152
    ds_read_b64_tr_b16 v[108:109], v7 offset:1280
    ds_read_b64_tr_b16 v[110:111], v7 offset:1408
    v_mfma_f32_32x32x16_bf16 v[32:47], v[88:91], v[120:123], 0
    v_mfma_f32_32x32x8_bf16 v[32:47], v[92:93], v[124:125], v[32:47]
    v_max3_f32 v13, v48, v49, v50
    v_max3_f32 v13, v13, v51, v52
    v_max3_f32 v13, v13, v53, v54
    v_max3_f32 v13, v13, v55, v56
    v_max3_f32 v13, v13, v57, v58
    v_max3_f32 v13, v13, v59, v60
    v_max3_f32 v13, v13, v61, v62
    v_max_f32 v13, v13, v63
    v_mov_b32 v14, v13
    s_nop 1
    v_permlane32_swap_b32 v13, v14
    v_max3_f32 v13, v13, v14, v12
    v_sub_f32 v14, v12, v13
    v_exp_f32 v14, v14
    v_mov_b32 v12, v13
    v_sub_f32 v48, v48, v13
    v_sub_f32 v49, v49, v13
    v_sub_f32 v50, v50, v13
    v_sub_f32 v51, v51, v13
    v_sub_f32 v52, v52, v13
    v_sub_f32 v53, v53, v13
    v_sub_f32 v54, v54, v13
    v_sub_f32 v55, v55, v13
    v_sub_f32 v56, v56, v13
    v_sub_f32 v57, v57, v13
    v_sub_f32 v58, v58, v13
    v_sub_f32 v59, v59, v13
    v_sub_f32 v60, v60, v13
    v_sub_f32 v61, v61, v13
    v_sub_f32 v62, v62, v13
    v_sub_f32 v63, v63, v13
    v_exp_f32 v48, v48
    v_exp_f32 v49, v49
    v_exp_f32 v50, v50
    v_exp_f32 v51, v51
    v_exp_f32 v52, v52
    v_exp_f32 v53, v53
    v_exp_f32 v54, v54
    v_exp_f32 v55, v55
    v_exp_f32 v56, v56
    v_exp_f32 v57, v57
    v_exp_f32 v58, v58
    v_exp_f32 v59, v59
    v_exp_f32 v60, v60
    v_exp_f32 v61, v61
    v_exp_f32 v62, v62
    v_exp_f32 v63, v63
    v_cvt_pk_bf16_f32 v64, v48, v49
    v_cvt_pk_bf16_f32 v65, v50, v51
    v_cvt_pk_bf16_f32 v66, v52, v53
    v_cvt_pk_bf16_f32 v67, v54, v55
    v_cvt_pk_bf16_f32 v68, v56, v57
    v_cvt_pk_bf16_f32 v69, v58, v59
    v_cvt_pk_bf16_f32 v70, v60, v61
    v_cvt_pk_bf16_f32 v71, v62, v63
    v_mul_f32 v72, v14, v72
    v_mul_f32 v73, v14, v73
    v_mul_f32 v74, v14, v74
    v_mul_f32 v75, v14, v75
    v_mul_f32 v76, v14, v76
    v_mul_f32 v77, v14, v77
    v_mul_f32 v78, v14, v78
    v_mul_f32 v79, v14, v79
    v_mul_f32 v80, v14, v80
    v_mul_f32 v81, v14, v81
    v_mul_f32 v82, v14, v82
    v_mul_f32 v83, v14, v83
    v_mul_f32 v84, v14, v84
    v_mul_f32 v85, v14, v85
    v_mul_f32 v86, v14, v86
    v_mul_f32 v87, v14, v87
    s_nop 1
    v_mfma_f32_32x32x16_bf16 v[72:87], v[112:115], v[64:67], v[72:87]
    v_mfma_f32_32x32x16_bf16 v[72:87], v[116:119], v[68:71], v[72:87]
    s_waitcnt lgkmcnt(0)
    ds_read_b128 v[88:91], v8 offset:0
    ds_read_b64 v[92:93], v9 offset:0
    ds_read_b64_tr_b16 v[112:113], v7 offset:1536
    ds_read_b64_tr_b16 v[114:115], v7 offset:1664
    ds_read_b64_tr_b16 v[116:117], v7 offset:1792
    ds_read_b64_tr_b16 v[118:119], v7 offset:1920
    v_mfma_f32_32x32x16_bf16 v[48:63], v[96:99], v[120:123], 0
    v_mfma_f32_32x32x8_bf16 v[48:63], v[100:101], v[124:125], v[48:63]
    v_max3_f32 v13, v32, v33, v34
    v_max3_f32 v13, v13, v35, v36
    v_max3_f32 v13, v13, v37, v38
    v_max3_f32 v13, v13, v39, v40
    v_max3_f32 v13, v13, v41, v42
    v_max3_f32 v13, v13, v43, v44
    v_max3_f32 v13, v13, v45, v46
    v_max_f32 v13, v13, v47
    v_mov_b32 v14, v13
    s_nop 1
    v_permlane32_swap_b32 v13, v14
    v_max3_f32 v13, v13, v14, v12
    v_sub_f32 v14, v12, v13
    v_exp_f32 v14, v14
    v_mov_b32 v12, v13
    v_sub_f32 v32, v32, v13
    v_sub_f32 v33, v33, v13
    v_sub_f32 v34, v34, v13
    v_sub_f32 v35, v35, v13
    v_sub_f32 v36, v36, v13
    v_sub_f32 v37, v37, v13
    v_sub_f32 v38, v38, v13
    v_sub_f32 v39, v39, v13
    v_sub_f32 v40, v40, v13
    v_sub_f32 v41, v41, v13
    v_sub_f32 v42, v42, v13
    v_sub_f32 v43, v43, v13
    v_sub_f32 v44, v44, v13
    v_sub_f32 v45, v45, v13
    v_sub_f32 v46, v46, v13
    v_sub_f32 v47, v47, v13
    v_exp_f32 v32, v32
    v_exp_f32 v33, v33
    v_exp_f32 v34, v34
    v_exp_f32 v35, v35
    v_exp_f32 v36, v36
    v_exp_f32 v37, v37
    v_exp_f32 v38, v38
    v_exp_f32 v39, v39
    v_exp_f32 v40, v40
    v_exp_f32 v41, v41
    v_exp_f32 v42, v42
    v_exp_f32 v43, v43
    v_exp_f32 v44, v44
    v_exp_f32 v45, v45
    v_exp_f32 v46, v46
    v_exp_f32 v47, v47
    v_cvt_pk_bf16_f32 v64, v32, v33
    v_cvt_pk_bf16_f32 v65, v34, v35
    v_cvt_pk_bf16_f32 v66, v36, v37
    v_cvt_pk_bf16_f32 v67, v38, v39
    v_cvt_pk_bf16_f32 v68, v40, v41
    v_cvt_pk_bf16_f32 v69, v42, v43
    v_cvt_pk_bf16_f32 v70, v44, v45
    v_cvt_pk_bf16_f32 v71, v46, v47
    v_mul_f32 v72, v14, v72
    v_mul_f32 v73, v14, v73
    v_mul_f32 v74, v14, v74
    v_mul_f32 v75, v14, v75
    v_mul_f32 v76, v14, v76
    v_mul_f32 v77, v14, v77
    v_mul_f32 v78, v14, v78
    v_mul_f32 v79, v14, v79
    v_mul_f32 v80, v14, v80
    v_mul_f32 v81, v14, v81
    v_mul_f32 v82, v14, v82
    v_mul_f32 v83, v14, v83
    v_mul_f32 v84, v14, v84
    v_mul_f32 v85, v14, v85
    v_mul_f32 v86, v14, v86
    v_mul_f32 v87, v14, v87
    s_nop 1
    v_mfma_f32_32x32x16_bf16 v[72:87], v[104:107], v[64:67], v[72:87]
    v_mfma_f32_32x32x16_bf16 v[72:87], v[108:111], v[68:71], v[72:87]
    s_waitcnt lgkmcnt(0)
    ds_read_b128 v[96:99], v8 offset:512
    ds_read_b64 v[100:101], v9 offset:512
    ds_read_b64_tr_b16 v[104:105], v10 offset:0
    ds_read_b64_tr_b16 v[106:107], v10 offset:128
    ds_read_b64_tr_b16 v[108:109], v10 offset:256
    ds_read_b64_tr_b16 v[110:111], v10 offset:384
    v_mfma_f32_32x32x16_bf16 v[32:47], v[88:91], v[120:123], 0
    v_mfma_f32_32x32x8_bf16 v[32:47], v[92:93], v[124:125], v[32:47]
    v_max3_f32 v13, v48, v49, v50
    v_max3_f32 v13, v13, v51, v52
    v_max3_f32 v13, v13, v53, v54
    v_max3_f32 v13, v13, v55, v56
    v_max3_f32 v13, v13, v57, v58
    v_max3_f32 v13, v13, v59, v60
    v_max3_f32 v13, v13, v61, v62
    v_max_f32 v13, v13, v63
    v_mov_b32 v14, v13
    s_nop 1
    v_permlane32_swap_b32 v13, v14
    v_max3_f32 v13, v13, v14, v12
    v_sub_f32 v14, v12, v13
    v_exp_f32 v14, v14
    v_mov_b32 v12, v13
    v_sub_f32 v48, v48, v13
    v_sub_f32 v49, v49, v13
    v_sub_f32 v50, v50, v13
    v_sub_f32 v51, v51, v13
    v_sub_f32 v52, v52, v13
    v_sub_f32 v53, v53, v13
    v_sub_f32 v54, v54, v13
    v_sub_f32 v55, v55, v13
    v_sub_f32 v56, v56, v13
    v_sub_f32 v57, v57, v13
    v_sub_f32 v58, v58, v13
    v_sub_f32 v59, v59, v13
    v_sub_f32 v60, v60, v13
    v_sub_f32 v61, v61, v13
    v_sub_f32 v62, v62, v13
    v_sub_f32 v63, v63, v13
    v_exp_f32 v48, v48
    v_exp_f32 v49, v49
    v_exp_f32 v50, v50
    v_exp_f32 v51, v51
    v_exp_f32 v52, v52
    v_exp_f32 v53, v53
    v_exp_f32 v54, v54
    v_exp_f32 v55, v55
    v_exp_f32 v56, v56
    v_exp_f32 v57, v57
    v_exp_f32 v58, v58
    v_exp_f32 v59, v59
    v_exp_f32 v60, v60
    v_exp_f32 v61, v61
    v_exp_f32 v62, v62
    v_exp_f32 v63, v63
    v_cvt_pk_bf16_f32 v64, v48, v49
    v_cvt_pk_bf16_f32 v65, v50, v51
    v_cvt_pk_bf16_f32 v66, v52, v53
    v_cvt_pk_bf16_f32 v67, v54, v55
    v_cvt_pk_bf16_f32 v68, v56, v57
    v_cvt_pk_bf16_f32 v69, v58, v59
    v_cvt_pk_bf16_f32 v70, v60, v61
    v_cvt_pk_bf16_f32 v71, v62, v63
    v_mul_f32 v72, v14, v72
    v_mul_f32 v73, v14, v73
    v_mul_f32 v74, v14, v74
    v_mul_f32 v75, v14, v75
    v_mul_f32 v76, v14, v76
    v_mul_f32 v77, v14, v77
    v_mul_f32 v78, v14, v78
    v_mul_f32 v79, v14, v79
    v_mul_f32 v80, v14, v80
    v_mul_f32 v81, v14, v81
    v_mul_f32 v82, v14, v82
    v_mul_f32 v83, v14, v83
    v_mul_f32 v84, v14, v84
    v_mul_f32 v85, v14, v85
    v_mul_f32 v86, v14, v86
    v_mul_f32 v87, v14, v87
    s_nop 1
    v_mfma_f32_32x32x16_bf16 v[72:87], v[112:115], v[64:67], v[72:87]
    v_mfma_f32_32x32x16_bf16 v[72:87], v[116:119], v[68:71], v[72:87]
    s_mov_b32 s34, s30
    s_mov_b32 s30, s31
    s_mov_b32 s31, s32
    s_mov_b32 s32, s34
    s_add_u32 s33, s33, 1
    s_cmp_lt_u32 s33, 8
    s_cbranch_scc1 K2_LOOPSL
K2_DONE:
    v_mov_b32 v16, v12
    s_lshr_b32 s42, s2, 3
    s_mul_i32 s42, s42, 51200
    s_add_u32 s42, s42, 21929984
    v_lshlrev_b32 v11, 7, v15
    v_cmp_gt_u32 vcc, 400, v15
    s_nop 1
    s_and_saveexec_b64 s[52:53], vcc
    s_cbranch_execz K2_NOPF
    buffer_load_dword v18, v11, s[12:15], s42 offen
K2_NOPF:
    s_mov_b64 exec, s[52:53]
    s_waitcnt lgkmcnt(0)
    s_barrier
    v_and_b32 v11, 31, v0
    v_lshrrev_b32 v12, 5, v0
    v_add_u32 v13, s46, v11
    v_lshrrev_b32 v126, 4, v13
    v_mul_u32_u24 v126, 40960, v126
    v_and_b32 v127, 15, v13
    v_lshl_add_u32 v10, v127, 4, v126
    s_mul_i32 s42, s20, 20
    v_lshlrev_b32 v14, 2, v12
    v_add_u32 v14, s42, v14
    s_mov_b32 s47, 16687104
    s_mul_i32 s43, s22, 3072
    v_add_u32 v8, 23552, v1
    v_add_u32 v8, s43, v8
    s_cmp_eq_u32 s35, 0
    s_cbranch_scc1 K2_EA
    ds_write_b128 v8, v[72:75] offset:0
    ds_write_b128 v8, v[76:79] offset:1024
    ds_write_b128 v8, v[80:83] offset:2048
    v_lshrrev_b32 v126, 2, v1
    v_add_u32 v126, s43, v126
    ds_write_b32 v126, v16 offset:48128
    s_waitcnt lgkmcnt(0)
    s_barrier
    v_mul_u32_u24 v13, 80, v11
    v_lshl_add_u32 v126, v12, 4, v13
    v_lshl_add_u32 v127, v12, 3, v13
    ds_read_b128 v[88:91], v126 offset:0
    ds_read_b128 v[92:95], v126 offset:32
    ds_read_b64 v[96:97], v127 offset:64
    s_lshl_b32 s44, s22, 9
    v_lshlrev_b32 v13, 4, v11
    v_add_u32 v13, s44, v13
    v_lshl_add_u32 v126, v12, 12, v13
    v_lshl_add_u32 v127, v12, 3, v13
    ds_read_b128 v[104:107], v126 offset:3072
    ds_read_b128 v[108:111], v126 offset:11264
    ds_read_b64 v[112:113], v127 offset:19456
    s_waitcnt lgkmcnt(0)
    v_mfma_f32_32x32x16_bf16 v[32:47], v[88:91], v[104:107], 0
    v_mfma_f32_32x32x16_bf16 v[32:47], v[92:95], v[108:111], v[32:47]
    v_mfma_f32_32x32x8_bf16 v[32:47], v[96:97], v[112:113], v[32:47]
    s_nop 11
    v_mov_b32 v126, v40
    v_mov_b32 v127, v40
    s_nop 1
    v_permlane32_swap_b32 v126, v127
    v_add_f32 v127, 897988541, v127
    v_rcp_f32 v9, v127
    s_nop 0
    v_mul_f32 v32, v9, v32
    v_mul_f32 v33, v9, v33
    v_mul_f32 v34, v9, v34
    v_mul_f32 v35, v9, v35
    v_mul_f32 v36, v9, v36
    v_mul_f32 v37, v9, v37
    v_mul_f32 v38, v9, v38
    v_mul_f32 v39, v9, v39
    v_mul_f32 v40, v9, v40
    v_mul_f32 v41, v9, v41
    v_mul_f32 v42, v9, v42
    v_mul_f32 v43, v9, v43
    v_cvt_pk_bf16_f32 v48, v32, v33
    v_cvt_pk_bf16_f32 v49, v34, v35
    v_cvt_pk_bf16_f32 v50, v36, v37
    v_cvt_pk_bf16_f32 v51, v38, v39
    v_cvt_pk_bf16_f32 v52, v40, v41
    v_cvt_pk_bf16_f32 v53, v42, v43
    v_add_u32 v13, 640, v14
    v_lshrrev_b32 v126, 5, v13
    v_lshlrev_b32 v126, 10, v126
    v_bfe_u32 v127, v13, 3, 2
    v_lshl_add_u32 v126, v127, 8, v126
    v_bfe_u32 v127, v13, 2, 1
    v_lshl_add_u32 v56, v127, 3, v126
    v_add_u32 v56, v56, v10
    v_add_u32 v13, 648, v14
    v_lshrrev_b32 v126, 5, v13
    v_lshlrev_b32 v126, 10, v126
    v_bfe_u32 v127, v13, 3, 2
    v_lshl_add_u32 v126, v127, 8, v126
    v_bfe_u32 v127, v13, 2, 1
    v_lshl_add_u32 v57, v127, 3, v126
    v_add_u32 v57, v57, v10
    v_add_u32 v13, 656, v14
    v_lshrrev_b32 v126, 5, v13
    v_lshlrev_b32 v126, 10, v126
    v_bfe_u32 v127, v13, 3, 2
    v_lshl_add_u32 v126, v127, 8, v126
    v_bfe_u32 v127, v13, 2, 1
    v_lshl_add_u32 v58, v127, 3, v126
    v_add_u32 v58, v58, v10
    buffer_store_dwordx2 v[48:49], v56, s[12:15], s47 offen
    buffer_store_dwordx2 v[50:51], v57, s[12:15], s47 offen
    s_mov_b64 s[52:53], exec
    s_mov_b32 exec_hi, 0
    buffer_store_dwordx2 v[52:53], v58, s[12:15], s47 offen
    s_mov_b64 exec, s[52:53]
    s_branch K2_EE
K2_EA:
    s_barrier
    ds_read_b128 v[32:35], v8 offset:0
    ds_read_b128 v[36:39], v8 offset:1024
    ds_read_b128 v[40:43], v8 offset:2048
    v_lshrrev_b32 v126, 2, v1
    v_add_u32 v126, s43, v126
    ds_read_b32 v17, v126 offset:48128
    s_waitcnt lgkmcnt(0)
    s_cmp_eq_u32 s59, 0
    s_cbranch_scc1 K2_MRG
    v_max_f32 v13, v16, v17
    v_sub_f32 v126, v16, v13
    v_sub_f32 v127, v17, v13
    v_exp_f32 v126, v126
    v_exp_f32 v127, v127
    v_mul_f32 v72, v126, v72
    v_mul_f32 v32, v127, v32
    v_mul_f32 v73, v126, v73
    v_mul_f32 v33, v127, v33
    v_mul_f32 v74, v126, v74
    v_mul_f32 v34, v127, v34
    v_mul_f32 v75, v126, v75
    v_mul_f32 v35, v127, v35
    v_mul_f32 v76, v126, v76
    v_mul_f32 v36, v127, v36
    v_mul_f32 v77, v126, v77
    v_mul_f32 v37, v127, v37
    v_mul_f32 v78, v126, v78
    v_mul_f32 v38, v127, v38
    v_mul_f32 v79, v126, v79
    v_mul_f32 v39, v127, v39
    v_mul_f32 v80, v126, v80
    v_mul_f32 v40, v127, v40
    v_mul_f32 v81, v126, v81
    v_mul_f32 v41, v127, v41
    v_mul_f32 v82, v126, v82
    v_mul_f32 v42, v127, v42
    v_mul_f32 v83, v126, v83
    v_mul_f32 v43, v127, v43
K2_MRG:
    v_add_f32 v72, v72, v32
    v_add_f32 v73, v73, v33
    v_add_f32 v74, v74, v34
    v_add_f32 v75, v75, v35
    v_add_f32 v76, v76, v36
    v_add_f32 v77, v77, v37
    v_add_f32 v78, v78, v38
    v_add_f32 v79, v79, v39
    v_add_f32 v80, v80, v40
    v_add_f32 v81, v81, v41
    v_add_f32 v82, v82, v42
    v_add_f32 v83, v83, v43
    v_mov_b32 v126, v80
    v_mov_b32 v127, v80
    s_nop 1
    v_permlane32_swap_b32 v126, v127
    v_rcp_f32 v9, v127
    s_nop 0
    v_mul_f32 v72, v9, v72
    v_mul_f32 v73, v9, v73
    v_mul_f32 v74, v9, v74
    v_mul_f32 v75, v9, v75
    v_mul_f32 v76, v9, v76
    v_mul_f32 v77, v9, v77
    v_mul_f32 v78, v9, v78
    v_mul_f32 v79, v9, v79
    v_mul_f32 v80, v9, v80
    v_mul_f32 v81, v9, v81
    v_mul_f32 v82, v9, v82
    v_mul_f32 v83, v9, v83
    v_cvt_pk_bf16_f32 v48, v72, v73
    v_cvt_pk_bf16_f32 v49, v74, v75
    v_cvt_pk_bf16_f32 v50, v76, v77
    v_cvt_pk_bf16_f32 v51, v78, v79
    v_cvt_pk_bf16_f32 v52, v80, v81
    v_cvt_pk_bf16_f32 v53, v82, v83
    v_add_u32 v13, 0, v14
    v_lshrrev_b32 v126, 5, v13
    v_lshlrev_b32 v126, 10, v126
    v_bfe_u32 v127, v13, 3, 2
    v_lshl_add_u32 v126, v127, 8, v126
    v_bfe_u32 v127, v13, 2, 1
    v_lshl_add_u32 v56, v127, 3, v126
    v_add_u32 v56, v56, v10
    v_add_u32 v13, 8, v14
    v_lshrrev_b32 v126, 5, v13
    v_lshlrev_b32 v126, 10, v126
    v_bfe_u32 v127, v13, 3, 2
    v_lshl_add_u32 v126, v127, 8, v126
    v_bfe_u32 v127, v13, 2, 1
    v_lshl_add_u32 v57, v127, 3, v126
    v_add_u32 v57, v57, v10
    v_add_u32 v13, 16, v14
    v_lshrrev_b32 v126, 5, v13
    v_lshlrev_b32 v126, 10, v126
    v_bfe_u32 v127, v13, 3, 2
    v_lshl_add_u32 v126, v127, 8, v126
    v_bfe_u32 v127, v13, 2, 1
    v_lshl_add_u32 v58, v127, 3, v126
    v_add_u32 v58, v58, v10
    buffer_store_dwordx2 v[48:49], v56, s[12:15], s47 offen
    buffer_store_dwordx2 v[50:51], v57, s[12:15], s47 offen
    s_mov_b64 s[52:53], exec
    s_mov_b32 exec_hi, 0
    buffer_store_dwordx2 v[52:53], v58, s[12:15], s47 offen
    s_mov_b64 exec, s[52:53]
K2_EE:
K2_END:
    s_endpgm
.globl k3_kernel
.p2align 8
.type k3_kernel,@function
k3_kernel:
    s_cmp_ge_u32 s2, 256
    s_cbranch_scc1 K3_END
    s_load_dwordx2 s[36:37], s[0:1], 64
    s_load_dwordx2 s[40:41], s[0:1], 80
    s_and_b32 s42, s2, 7
    s_lshr_b32 s43, s2, 3
    s_lshl_b32 s42, s42, 2
    s_and_b32 s44, s43, 3
    s_add_u32 s20, s42, s44
    s_lshr_b32 s21, s43, 2
    v_lshrrev_b32 v14, 6, v0
    v_and_b32 v0, 63, v0
    v_readfirstlane_b32 s23, v14
    v_lshlrev_b32 v1, 4, v0
    s_waitcnt lgkmcnt(0)
    s_mov_b32 s12, s40
    s_and_b32 s13, s41, 0xffff
    s_mov_b32 s14, 23568384
    s_mov_b32 s15, 0x00020000
    s_mov_b32 s16, s36
    s_and_b32 s17, s37, 0xffff
    s_mov_b32 s18, 2621440
    s_mov_b32 s19, 0x00020000
    s_mul_i32 s42, s21, 40
    s_mul_i32 s43, s23, 10
    s_add_u32 s42, s42, s43
    s_mul_i32 s24, s42, 5120
    s_add_u32 s24, s24, 21929984
    s_mul_i32 s42, s20, 163840
    s_lshl_b32 s43, s43, 10
    s_add_u32 s25, s42, s43
    s_add_u32 s25, s25, 16687104
    v_mov_b32 v2, v1
    v_add_u32 v8, 4096, v1
    v_add_u32 v3, 40960, v1
    v_add_u32 v4, 81920, v1
    v_add_u32 v5, 122880, v1
    buffer_load_dwordx4 a[0:3], v1, s[12:15], s24 offen offset:0
    buffer_load_dwordx4 a[4:7], v1, s[12:15], s24 offen offset:1024
    buffer_load_dwordx4 a[8:11], v1, s[12:15], s24 offen offset:2048
    buffer_load_dwordx4 a[12:15], v1, s[12:15], s24 offen offset:3072
    buffer_load_dwordx4 a[16:19], v8, s[12:15], s24 offen
    buffer_load_dwordx4 a[20:23], v2, s[12:15], s25 offen
    buffer_load_dwordx4 a[24:27], v3, s[12:15], s25 offen
    buffer_load_dwordx4 a[28:31], v4, s[12:15], s25 offen
    buffer_load_dwordx4 a[32:35], v5, s[12:15], s25 offen
    s_add_u32 s24, s24, 5120
    s_add_u32 s25, s25, 1024
    v_mov_b32 v16, 0
    v_mov_b32 v17, 0
    v_mov_b32 v18, 0
    v_mov_b32 v19, 0
    v_mov_b32 v20, 0
    v_mov_b32 v21, 0
    v_mov_b32 v22, 0
    v_mov_b32 v23, 0
    v_mov_b32 v24, 0
    v_mov_b32 v25, 0
    v_mov_b32 v26, 0
    v_mov_b32 v27, 0
    v_mov_b32 v28, 0
    v_mov_b32 v29, 0
    v_mov_b32 v30, 0
    v_mov_b32 v31, 0
    v_mov_b32 v32, 0
    v_mov_b32 v33, 0
    v_mov_b32 v34, 0
    v_mov_b32 v35, 0
    v_mov_b32 v36, 0
    v_mov_b32 v37, 0
    v_mov_b32 v38, 0
    v_mov_b32 v39, 0
    v_mov_b32 v40, 0
    v_mov_b32 v41, 0
    v_mov_b32 v42, 0
    v_mov_b32 v43, 0
    v_mov_b32 v44, 0
    v_mov_b32 v45, 0
    v_mov_b32 v46, 0
    v_mov_b32 v47, 0
    v_mov_b32 v48, 0
    v_mov_b32 v49, 0
    v_mov_b32 v50, 0
    v_mov_b32 v51, 0
    v_mov_b32 v52, 0
    v_mov_b32 v53, 0
    v_mov_b32 v54, 0
    v_mov_b32 v55, 0
    v_mov_b32 v56, 0
    v_mov_b32 v57, 0
    v_mov_b32 v58, 0
    v_mov_b32 v59, 0
    v_mov_b32 v60, 0
    v_mov_b32 v61, 0
    v_mov_b32 v62, 0
    v_mov_b32 v63, 0
    v_mov_b32 v64, 0
    v_mov_b32 v65, 0
    v_mov_b32 v66, 0
    v_mov_b32 v67, 0
    v_mov_b32 v68, 0
    v_mov_b32 v69, 0
    v_mov_b32 v70, 0
    v_mov_b32 v71, 0
    v_mov_b32 v72, 0
    v_mov_b32 v73, 0
    v_mov_b32 v74, 0
    v_mov_b32 v75, 0
    v_mov_b32 v76, 0
    v_mov_b32 v77, 0
    v_mov_b32 v78, 0
    v_mov_b32 v79, 0
    v_mov_b32 v80, 0
    v_mov_b32 v81, 0
    v_mov_b32 v82, 0
    v_mov_b32 v83, 0
    v_mov_b32 v84, 0
    v_mov_b32 v85, 0
    v_mov_b32 v86, 0
    v_mov_b32 v87, 0
    v_mov_b32 v88, 0
    v_mov_b32 v89, 0
    v_mov_b32 v90, 0
    v_mov_b32 v91, 0
    v_mov_b32 v92, 0
    v_mov_b32 v93, 0
    v_mov_b32 v94, 0
    v_mov_b32 v95, 0
    buffer_load_dwordx4 a[36:39], v1, s[12:15], s24 offen offset:0
    buffer_load_dwordx4 a[40:43], v1, s[12:15], s24 offen offset:1024
    buffer_load_dwordx4 a[44:47], v1, s[12:15], s24 offen offset:2048
    buffer_load_dwordx4 a[48:51], v1, s[12:15], s24 offen offset:3072
    buffer_load_dwordx4 a[52:55], v8, s[12:15], s24 offen
    buffer_load_dwordx4 a[56:59], v2, s[12:15], s25 offen
    buffer_load_dwordx4 a[60:63], v3, s[12:15], s25 offen
    buffer_load_dwordx4 a[64:67], v4, s[12:15], s25 offen
    buffer_load_dwordx4 a[68:71], v5, s[12:15], s25 offen
    s_add_u32 s24, s24, 5120
    s_add_u32 s25, s25, 1024
    buffer_load_dwordx4 a[72:75], v1, s[12:15], s24 offen offset:0
    buffer_load_dwordx4 a[76:79], v1, s[12:15], s24 offen offset:1024
    buffer_load_dwordx4 a[80:83], v1, s[12:15], s24 offen offset:2048
    buffer_load_dwordx4 a[84:87], v1, s[12:15], s24 offen offset:3072
    buffer_load_dwordx4 a[88:91], v8, s[12:15], s24 offen
    buffer_load_dwordx4 a[92:95], v2, s[12:15], s25 offen
    buffer_load_dwordx4 a[96:99], v3, s[12:15], s25 offen
    buffer_load_dwordx4 a[100:103], v4, s[12:15], s25 offen
    buffer_load_dwordx4 a[104:107], v5, s[12:15], s25 offen
    s_add_u32 s24, s24, 5120
    s_add_u32 s25, s25, 1024
    buffer_load_dwordx4 a[108:111], v1, s[12:15], s24 offen offset:0
    buffer_load_dwordx4 a[112:115], v1, s[12:15], s24 offen offset:1024
    buffer_load_dwordx4 a[116:119], v1, s[12:15], s24 offen offset:2048
    buffer_load_dwordx4 a[120:123], v1, s[12:15], s24 offen offset:3072
    buffer_load_dwordx4 a[124:127], v8, s[12:15], s24 offen
    buffer_load_dwordx4 a[128:131], v2, s[12:15], s25 offen
    buffer_load_dwordx4 a[132:135], v3, s[12:15], s25 offen
    buffer_load_dwordx4 a[136:139], v4, s[12:15], s25 offen
    buffer_load_dwordx4 a[140:143], v5, s[12:15], s25 offen
    s_add_u32 s24, s24, 5120
    s_add_u32 s25, s25, 1024
    v_and_b32 v6, 15, v0
    v_lshrrev_b32 v7, 4, v0
    s_lshl_b32 s42, s20, 6
    s_lshl_b32 s43, s23, 4
    s_add_u32 s46, s42, s43
    v_add_lshl_u32 v14, s46, v6, 2
    s_mov_b32 s43, 9715712
    buffer_load_dword v100, v14, s[12:15], s43 offen
    s_waitcnt vmcnt(28)
    v_mfma_f32_16x16x32_bf16 v[16:19], a[0:3], a[20:23], v[16:19]
    v_mfma_f32_16x16x32_bf16 v[20:23], a[0:3], a[24:27], v[20:23]
    v_mfma_f32_16x16x32_bf16 v[24:27], a[0:3], a[28:31], v[24:27]
    v_mfma_f32_16x16x32_bf16 v[28:31], a[0:3], a[32:35], v[28:31]
    v_mfma_f32_16x16x32_bf16 v[32:35], a[4:7], a[20:23], v[32:35]
    v_mfma_f32_16x16x32_bf16 v[36:39], a[4:7], a[24:27], v[36:39]
    v_mfma_f32_16x16x32_bf16 v[40:43], a[4:7], a[28:31], v[40:43]
    v_mfma_f32_16x16x32_bf16 v[44:47], a[4:7], a[32:35], v[44:47]
    v_mfma_f32_16x16x32_bf16 v[48:51], a[8:11], a[20:23], v[48:51]
    v_mfma_f32_16x16x32_bf16 v[52:55], a[8:11], a[24:27], v[52:55]
    v_mfma_f32_16x16x32_bf16 v[56:59], a[8:11], a[28:31], v[56:59]
    v_mfma_f32_16x16x32_bf16 v[60:63], a[8:11], a[32:35], v[60:63]
    v_mfma_f32_16x16x32_bf16 v[64:67], a[12:15], a[20:23], v[64:67]
    v_mfma_f32_16x16x32_bf16 v[68:71], a[12:15], a[24:27], v[68:71]
    v_mfma_f32_16x16x32_bf16 v[72:75], a[12:15], a[28:31], v[72:75]
    v_mfma_f32_16x16x32_bf16 v[76:79], a[12:15], a[32:35], v[76:79]
    v_mfma_f32_16x16x32_bf16 v[80:83], a[16:19], a[20:23], v[80:83]
    v_mfma_f32_16x16x32_bf16 v[84:87], a[16:19], a[24:27], v[84:87]
    v_mfma_f32_16x16x32_bf16 v[88:91], a[16:19], a[28:31], v[88:91]
    v_mfma_f32_16x16x32_bf16 v[92:95], a[16:19], a[32:35], v[92:95]
    buffer_load_dwordx4 a[0:3], v1, s[12:15], s24 offen offset:0
    buffer_load_dwordx4 a[4:7], v1, s[12:15], s24 offen offset:1024
    buffer_load_dwordx4 a[8:11], v1, s[12:15], s24 offen offset:2048
    buffer_load_dwordx4 a[12:15], v1, s[12:15], s24 offen offset:3072
    buffer_load_dwordx4 a[16:19], v8, s[12:15], s24 offen
    buffer_load_dwordx4 a[20:23], v2, s[12:15], s25 offen
    buffer_load_dwordx4 a[24:27], v3, s[12:15], s25 offen
    buffer_load_dwordx4 a[28:31], v4, s[12:15], s25 offen
    buffer_load_dwordx4 a[32:35], v5, s[12:15], s25 offen
    s_add_u32 s24, s24, 5120
    s_add_u32 s25, s25, 1024
    s_waitcnt vmcnt(28)
    v_mfma_f32_16x16x32_bf16 v[16:19], a[36:39], a[56:59], v[16:19]
    v_mfma_f32_16x16x32_bf16 v[20:23], a[36:39], a[60:63], v[20:23]
    v_mfma_f32_16x16x32_bf16 v[24:27], a[36:39], a[64:67], v[24:27]
    v_mfma_f32_16x16x32_bf16 v[28:31], a[36:39], a[68:71], v[28:31]
    v_mfma_f32_16x16x32_bf16 v[32:35], a[40:43], a[56:59], v[32:35]
    v_mfma_f32_16x16x32_bf16 v[36:39], a[40:43], a[60:63], v[36:39]
    v_mfma_f32_16x16x32_bf16 v[40:43], a[40:43], a[64:67], v[40:43]
    v_mfma_f32_16x16x32_bf16 v[44:47], a[40:43], a[68:71], v[44:47]
    v_mfma_f32_16x16x32_bf16 v[48:51], a[44:47], a[56:59], v[48:51]
    v_mfma_f32_16x16x32_bf16 v[52:55], a[44:47], a[60:63], v[52:55]
    v_mfma_f32_16x16x32_bf16 v[56:59], a[44:47], a[64:67], v[56:59]
    v_mfma_f32_16x16x32_bf16 v[60:63], a[44:47], a[68:71], v[60:63]
    v_mfma_f32_16x16x32_bf16 v[64:67], a[48:51], a[56:59], v[64:67]
    v_mfma_f32_16x16x32_bf16 v[68:71], a[48:51], a[60:63], v[68:71]
    v_mfma_f32_16x16x32_bf16 v[72:75], a[48:51], a[64:67], v[72:75]
    v_mfma_f32_16x16x32_bf16 v[76:79], a[48:51], a[68:71], v[76:79]
    v_mfma_f32_16x16x32_bf16 v[80:83], a[52:55], a[56:59], v[80:83]
    v_mfma_f32_16x16x32_bf16 v[84:87], a[52:55], a[60:63], v[84:87]
    v_mfma_f32_16x16x32_bf16 v[88:91], a[52:55], a[64:67], v[88:91]
    v_mfma_f32_16x16x32_bf16 v[92:95], a[52:55], a[68:71], v[92:95]
    buffer_load_dwordx4 a[36:39], v1, s[12:15], s24 offen offset:0
    buffer_load_dwordx4 a[40:43], v1, s[12:15], s24 offen offset:1024
    buffer_load_dwordx4 a[44:47], v1, s[12:15], s24 offen offset:2048
    buffer_load_dwordx4 a[48:51], v1, s[12:15], s24 offen offset:3072
    buffer_load_dwordx4 a[52:55], v8, s[12:15], s24 offen
    buffer_load_dwordx4 a[56:59], v2, s[12:15], s25 offen
    buffer_load_dwordx4 a[60:63], v3, s[12:15], s25 offen
    buffer_load_dwordx4 a[64:67], v4, s[12:15], s25 offen
    buffer_load_dwordx4 a[68:71], v5, s[12:15], s25 offen
    s_add_u32 s24, s24, 5120
    s_add_u32 s25, s25, 1024
    s_waitcnt vmcnt(28)
    v_mfma_f32_16x16x32_bf16 v[16:19], a[72:75], a[92:95], v[16:19]
    v_mfma_f32_16x16x32_bf16 v[20:23], a[72:75], a[96:99], v[20:23]
    v_mfma_f32_16x16x32_bf16 v[24:27], a[72:75], a[100:103], v[24:27]
    v_mfma_f32_16x16x32_bf16 v[28:31], a[72:75], a[104:107], v[28:31]
    v_mfma_f32_16x16x32_bf16 v[32:35], a[76:79], a[92:95], v[32:35]
    v_mfma_f32_16x16x32_bf16 v[36:39], a[76:79], a[96:99], v[36:39]
    v_mfma_f32_16x16x32_bf16 v[40:43], a[76:79], a[100:103], v[40:43]
    v_mfma_f32_16x16x32_bf16 v[44:47], a[76:79], a[104:107], v[44:47]
    v_mfma_f32_16x16x32_bf16 v[48:51], a[80:83], a[92:95], v[48:51]
    v_mfma_f32_16x16x32_bf16 v[52:55], a[80:83], a[96:99], v[52:55]
    v_mfma_f32_16x16x32_bf16 v[56:59], a[80:83], a[100:103], v[56:59]
    v_mfma_f32_16x16x32_bf16 v[60:63], a[80:83], a[104:107], v[60:63]
    v_mfma_f32_16x16x32_bf16 v[64:67], a[84:87], a[92:95], v[64:67]
    v_mfma_f32_16x16x32_bf16 v[68:71], a[84:87], a[96:99], v[68:71]
    v_mfma_f32_16x16x32_bf16 v[72:75], a[84:87], a[100:103], v[72:75]
    v_mfma_f32_16x16x32_bf16 v[76:79], a[84:87], a[104:107], v[76:79]
    v_mfma_f32_16x16x32_bf16 v[80:83], a[88:91], a[92:95], v[80:83]
    v_mfma_f32_16x16x32_bf16 v[84:87], a[88:91], a[96:99], v[84:87]
    v_mfma_f32_16x16x32_bf16 v[88:91], a[88:91], a[100:103], v[88:91]
    v_mfma_f32_16x16x32_bf16 v[92:95], a[88:91], a[104:107], v[92:95]
    buffer_load_dwordx4 a[72:75], v1, s[12:15], s24 offen offset:0
    buffer_load_dwordx4 a[76:79], v1, s[12:15], s24 offen offset:1024
    buffer_load_dwordx4 a[80:83], v1, s[12:15], s24 offen offset:2048
    buffer_load_dwordx4 a[84:87], v1, s[12:15], s24 offen offset:3072
    buffer_load_dwordx4 a[88:91], v8, s[12:15], s24 offen
    buffer_load_dwordx4 a[92:95], v2, s[12:15], s25 offen
    buffer_load_dwordx4 a[96:99], v3, s[12:15], s25 offen
    buffer_load_dwordx4 a[100:103], v4, s[12:15], s25 offen
    buffer_load_dwordx4 a[104:107], v5, s[12:15], s25 offen
    s_add_u32 s24, s24, 5120
    s_add_u32 s25, s25, 1024
    s_waitcnt vmcnt(28)
    v_mfma_f32_16x16x32_bf16 v[16:19], a[108:111], a[128:131], v[16:19]
    v_mfma_f32_16x16x32_bf16 v[20:23], a[108:111], a[132:135], v[20:23]
    v_mfma_f32_16x16x32_bf16 v[24:27], a[108:111], a[136:139], v[24:27]
    v_mfma_f32_16x16x32_bf16 v[28:31], a[108:111], a[140:143], v[28:31]
    v_mfma_f32_16x16x32_bf16 v[32:35], a[112:115], a[128:131], v[32:35]
    v_mfma_f32_16x16x32_bf16 v[36:39], a[112:115], a[132:135], v[36:39]
    v_mfma_f32_16x16x32_bf16 v[40:43], a[112:115], a[136:139], v[40:43]
    v_mfma_f32_16x16x32_bf16 v[44:47], a[112:115], a[140:143], v[44:47]
    v_mfma_f32_16x16x32_bf16 v[48:51], a[116:119], a[128:131], v[48:51]
    v_mfma_f32_16x16x32_bf16 v[52:55], a[116:119], a[132:135], v[52:55]
    v_mfma_f32_16x16x32_bf16 v[56:59], a[116:119], a[136:139], v[56:59]
    v_mfma_f32_16x16x32_bf16 v[60:63], a[116:119], a[140:143], v[60:63]
    v_mfma_f32_16x16x32_bf16 v[64:67], a[120:123], a[128:131], v[64:67]
    v_mfma_f32_16x16x32_bf16 v[68:71], a[120:123], a[132:135], v[68:71]
    v_mfma_f32_16x16x32_bf16 v[72:75], a[120:123], a[136:139], v[72:75]
    v_mfma_f32_16x16x32_bf16 v[76:79], a[120:123], a[140:143], v[76:79]
    v_mfma_f32_16x16x32_bf16 v[80:83], a[124:127], a[128:131], v[80:83]
    v_mfma_f32_16x16x32_bf16 v[84:87], a[124:127], a[132:135], v[84:87]
    v_mfma_f32_16x16x32_bf16 v[88:91], a[124:127], a[136:139], v[88:91]
    v_mfma_f32_16x16x32_bf16 v[92:95], a[124:127], a[140:143], v[92:95]
    buffer_load_dwordx4 a[108:111], v1, s[12:15], s24 offen offset:0
    buffer_load_dwordx4 a[112:115], v1, s[12:15], s24 offen offset:1024
    buffer_load_dwordx4 a[116:119], v1, s[12:15], s24 offen offset:2048
    buffer_load_dwordx4 a[120:123], v1, s[12:15], s24 offen offset:3072
    buffer_load_dwordx4 a[124:127], v8, s[12:15], s24 offen
    buffer_load_dwordx4 a[128:131], v2, s[12:15], s25 offen
    buffer_load_dwordx4 a[132:135], v3, s[12:15], s25 offen
    buffer_load_dwordx4 a[136:139], v4, s[12:15], s25 offen
    buffer_load_dwordx4 a[140:143], v5, s[12:15], s25 offen
    s_add_u32 s24, s24, 5120
    s_add_u32 s25, s25, 1024
    s_waitcnt vmcnt(27)
    v_mfma_f32_16x16x32_bf16 v[16:19], a[0:3], a[20:23], v[16:19]
    v_mfma_f32_16x16x32_bf16 v[20:23], a[0:3], a[24:27], v[20:23]
    v_mfma_f32_16x16x32_bf16 v[24:27], a[0:3], a[28:31], v[24:27]
    v_mfma_f32_16x16x32_bf16 v[28:31], a[0:3], a[32:35], v[28:31]
    v_mfma_f32_16x16x32_bf16 v[32:35], a[4:7], a[20:23], v[32:35]
    v_mfma_f32_16x16x32_bf16 v[36:39], a[4:7], a[24:27], v[36:39]
    v_mfma_f32_16x16x32_bf16 v[40:43], a[4:7], a[28:31], v[40:43]
    v_mfma_f32_16x16x32_bf16 v[44:47], a[4:7], a[32:35], v[44:47]
    v_mfma_f32_16x16x32_bf16 v[48:51], a[8:11], a[20:23], v[48:51]
    v_mfma_f32_16x16x32_bf16 v[52:55], a[8:11], a[24:27], v[52:55]
    v_mfma_f32_16x16x32_bf16 v[56:59], a[8:11], a[28:31], v[56:59]
    v_mfma_f32_16x16x32_bf16 v[60:63], a[8:11], a[32:35], v[60:63]
    v_mfma_f32_16x16x32_bf16 v[64:67], a[12:15], a[20:23], v[64:67]
    v_mfma_f32_16x16x32_bf16 v[68:71], a[12:15], a[24:27], v[68:71]
    v_mfma_f32_16x16x32_bf16 v[72:75], a[12:15], a[28:31], v[72:75]
    v_mfma_f32_16x16x32_bf16 v[76:79], a[12:15], a[32:35], v[76:79]
    v_mfma_f32_16x16x32_bf16 v[80:83], a[16:19], a[20:23], v[80:83]
    v_mfma_f32_16x16x32_bf16 v[84:87], a[16:19], a[24:27], v[84:87]
    v_mfma_f32_16x16x32_bf16 v[88:91], a[16:19], a[28:31], v[88:91]
    v_mfma_f32_16x16x32_bf16 v[92:95], a[16:19], a[32:35], v[92:95]
    buffer_load_dwordx4 a[0:3], v1, s[12:15], s24 offen offset:0
    buffer_load_dwordx4 a[4:7], v1, s[12:15], s24 offen offset:1024
    buffer_load_dwordx4 a[8:11], v1, s[12:15], s24 offen offset:2048
    buffer_load_dwordx4 a[12:15], v1, s[12:15], s24 offen offset:3072
    buffer_load_dwordx4 a[16:19], v8, s[12:15], s24 offen
    buffer_load_dwordx4 a[20:23], v2, s[12:15], s25 offen
    buffer_load_dwordx4 a[24:27], v3, s[12:15], s25 offen
    buffer_load_dwordx4 a[28:31], v4, s[12:15], s25 offen
    buffer_load_dwordx4 a[32:35], v5, s[12:15], s25 offen
    s_add_u32 s24, s24, 5120
    s_add_u32 s25, s25, 1024
    s_waitcnt vmcnt(27)
    v_mfma_f32_16x16x32_bf16 v[16:19], a[36:39], a[56:59], v[16:19]
    v_mfma_f32_16x16x32_bf16 v[20:23], a[36:39], a[60:63], v[20:23]
    v_mfma_f32_16x16x32_bf16 v[24:27], a[36:39], a[64:67], v[24:27]
    v_mfma_f32_16x16x32_bf16 v[28:31], a[36:39], a[68:71], v[28:31]
    v_mfma_f32_16x16x32_bf16 v[32:35], a[40:43], a[56:59], v[32:35]
    v_mfma_f32_16x16x32_bf16 v[36:39], a[40:43], a[60:63], v[36:39]
    v_mfma_f32_16x16x32_bf16 v[40:43], a[40:43], a[64:67], v[40:43]
    v_mfma_f32_16x16x32_bf16 v[44:47], a[40:43], a[68:71], v[44:47]
    v_mfma_f32_16x16x32_bf16 v[48:51], a[44:47], a[56:59], v[48:51]
    v_mfma_f32_16x16x32_bf16 v[52:55], a[44:47], a[60:63], v[52:55]
    v_mfma_f32_16x16x32_bf16 v[56:59], a[44:47], a[64:67], v[56:59]
    v_mfma_f32_16x16x32_bf16 v[60:63], a[44:47], a[68:71], v[60:63]
    v_mfma_f32_16x16x32_bf16 v[64:67], a[48:51], a[56:59], v[64:67]
    v_mfma_f32_16x16x32_bf16 v[68:71], a[48:51], a[60:63], v[68:71]
    v_mfma_f32_16x16x32_bf16 v[72:75], a[48:51], a[64:67], v[72:75]
    v_mfma_f32_16x16x32_bf16 v[76:79], a[48:51], a[68:71], v[76:79]
    v_mfma_f32_16x16x32_bf16 v[80:83], a[52:55], a[56:59], v[80:83]
    v_mfma_f32_16x16x32_bf16 v[84:87], a[52:55], a[60:63], v[84:87]
    v_mfma_f32_16x16x32_bf16 v[88:91], a[52:55], a[64:67], v[88:91]
    v_mfma_f32_16x16x32_bf16 v[92:95], a[52:55], a[68:71], v[92:95]
    buffer_load_dwordx4 a[36:39], v1, s[12:15], s24 offen offset:0
    buffer_load_dwordx4 a[40:43], v1, s[12:15], s24 offen offset:1024
    buffer_load_dwordx4 a[44:47], v1, s[12:15], s24 offen offset:2048
    buffer_load_dwordx4 a[48:51], v1, s[12:15], s24 offen offset:3072
    buffer_load_dwordx4 a[52:55], v8, s[12:15], s24 offen
    buffer_load_dwordx4 a[56:59], v2, s[12:15], s25 offen
    buffer_load_dwordx4 a[60:63], v3, s[12:15], s25 offen
    buffer_load_dwordx4 a[64:67], v4, s[12:15], s25 offen
    buffer_load_dwordx4 a[68:71], v5, s[12:15], s25 offen
    s_add_u32 s24, s24, 5120
    s_add_u32 s25, s25, 1024
    s_waitcnt vmcnt(27)
    v_mfma_f32_16x16x32_bf16 v[16:19], a[72:75], a[92:95], v[16:19]
    v_mfma_f32_16x16x32_bf16 v[20:23], a[72:75], a[96:99], v[20:23]
    v_mfma_f32_16x16x32_bf16 v[24:27], a[72:75], a[100:103], v[24:27]
    v_mfma_f32_16x16x32_bf16 v[28:31], a[72:75], a[104:107], v[28:31]
    v_mfma_f32_16x16x32_bf16 v[32:35], a[76:79], a[92:95], v[32:35]
    v_mfma_f32_16x16x32_bf16 v[36:39], a[76:79], a[96:99], v[36:39]
    v_mfma_f32_16x16x32_bf16 v[40:43], a[76:79], a[100:103], v[40:43]
    v_mfma_f32_16x16x32_bf16 v[44:47], a[76:79], a[104:107], v[44:47]
    v_mfma_f32_16x16x32_bf16 v[48:51], a[80:83], a[92:95], v[48:51]
    v_mfma_f32_16x16x32_bf16 v[52:55], a[80:83], a[96:99], v[52:55]
    v_mfma_f32_16x16x32_bf16 v[56:59], a[80:83], a[100:103], v[56:59]
    v_mfma_f32_16x16x32_bf16 v[60:63], a[80:83], a[104:107], v[60:63]
    v_mfma_f32_16x16x32_bf16 v[64:67], a[84:87], a[92:95], v[64:67]
    v_mfma_f32_16x16x32_bf16 v[68:71], a[84:87], a[96:99], v[68:71]
    v_mfma_f32_16x16x32_bf16 v[72:75], a[84:87], a[100:103], v[72:75]
    v_mfma_f32_16x16x32_bf16 v[76:79], a[84:87], a[104:107], v[76:79]
    v_mfma_f32_16x16x32_bf16 v[80:83], a[88:91], a[92:95], v[80:83]
    v_mfma_f32_16x16x32_bf16 v[84:87], a[88:91], a[96:99], v[84:87]
    v_mfma_f32_16x16x32_bf16 v[88:91], a[88:91], a[100:103], v[88:91]
    v_mfma_f32_16x16x32_bf16 v[92:95], a[88:91], a[104:107], v[92:95]
    s_waitcnt vmcnt(18)
    v_mfma_f32_16x16x32_bf16 v[16:19], a[108:111], a[128:131], v[16:19]
    v_mfma_f32_16x16x32_bf16 v[20:23], a[108:111], a[132:135], v[20:23]
    v_mfma_f32_16x16x32_bf16 v[24:27], a[108:111], a[136:139], v[24:27]
    v_mfma_f32_16x16x32_bf16 v[28:31], a[108:111], a[140:143], v[28:31]
    v_mfma_f32_16x16x32_bf16 v[32:35], a[112:115], a[128:131], v[32:35]
    v_mfma_f32_16x16x32_bf16 v[36:39], a[112:115], a[132:135], v[36:39]
    v_mfma_f32_16x16x32_bf16 v[40:43], a[112:115], a[136:139], v[40:43]
    v_mfma_f32_16x16x32_bf16 v[44:47], a[112:115], a[140:143], v[44:47]
    v_mfma_f32_16x16x32_bf16 v[48:51], a[116:119], a[128:131], v[48:51]
    v_mfma_f32_16x16x32_bf16 v[52:55], a[116:119], a[132:135], v[52:55]
    v_mfma_f32_16x16x32_bf16 v[56:59], a[116:119], a[136:139], v[56:59]
    v_mfma_f32_16x16x32_bf16 v[60:63], a[116:119], a[140:143], v[60:63]
    v_mfma_f32_16x16x32_bf16 v[64:67], a[120:123], a[128:131], v[64:67]
    v_mfma_f32_16x16x32_bf16 v[68:71], a[120:123], a[132:135], v[68:71]
    v_mfma_f32_16x16x32_bf16 v[72:75], a[120:123], a[136:139], v[72:75]
    v_mfma_f32_16x16x32_bf16 v[76:79], a[120:123], a[140:143], v[76:79]
    v_mfma_f32_16x16x32_bf16 v[80:83], a[124:127], a[128:131], v[80:83]
    v_mfma_f32_16x16x32_bf16 v[84:87], a[124:127], a[132:135], v[84:87]
    v_mfma_f32_16x16x32_bf16 v[88:91], a[124:127], a[136:139], v[88:91]
    v_mfma_f32_16x16x32_bf16 v[92:95], a[124:127], a[140:143], v[92:95]
    s_waitcnt vmcnt(9)
    v_mfma_f32_16x16x32_bf16 v[16:19], a[0:3], a[20:23], v[16:19]
    v_mfma_f32_16x16x32_bf16 v[20:23], a[0:3], a[24:27], v[20:23]
    v_mfma_f32_16x16x32_bf16 v[24:27], a[0:3], a[28:31], v[24:27]
    v_mfma_f32_16x16x32_bf16 v[28:31], a[0:3], a[32:35], v[28:31]
    v_mfma_f32_16x16x32_bf16 v[32:35], a[4:7], a[20:23], v[32:35]
    v_mfma_f32_16x16x32_bf16 v[36:39], a[4:7], a[24:27], v[36:39]
    v_mfma_f32_16x16x32_bf16 v[40:43], a[4:7], a[28:31], v[40:43]
    v_mfma_f32_16x16x32_bf16 v[44:47], a[4:7], a[32:35], v[44:47]
    v_mfma_f32_16x16x32_bf16 v[48:51], a[8:11], a[20:23], v[48:51]
    v_mfma_f32_16x16x32_bf16 v[52:55], a[8:11], a[24:27], v[52:55]
    v_mfma_f32_16x16x32_bf16 v[56:59], a[8:11], a[28:31], v[56:59]
    v_mfma_f32_16x16x32_bf16 v[60:63], a[8:11], a[32:35], v[60:63]
    v_mfma_f32_16x16x32_bf16 v[64:67], a[12:15], a[20:23], v[64:67]
    v_mfma_f32_16x16x32_bf16 v[68:71], a[12:15], a[24:27], v[68:71]
    v_mfma_f32_16x16x32_bf16 v[72:75], a[12:15], a[28:31], v[72:75]
    v_mfma_f32_16x16x32_bf16 v[76:79], a[12:15], a[32:35], v[76:79]
    v_mfma_f32_16x16x32_bf16 v[80:83], a[16:19], a[20:23], v[80:83]
    v_mfma_f32_16x16x32_bf16 v[84:87], a[16:19], a[24:27], v[84:87]
    v_mfma_f32_16x16x32_bf16 v[88:91], a[16:19], a[28:31], v[88:91]
    v_mfma_f32_16x16x32_bf16 v[92:95], a[16:19], a[32:35], v[92:95]
    s_waitcnt vmcnt(0)
    v_mfma_f32_16x16x32_bf16 v[16:19], a[36:39], a[56:59], v[16:19]
    v_mfma_f32_16x16x32_bf16 v[20:23], a[36:39], a[60:63], v[20:23]
    v_mfma_f32_16x16x32_bf16 v[24:27], a[36:39], a[64:67], v[24:27]
    v_mfma_f32_16x16x32_bf16 v[28:31], a[36:39], a[68:71], v[28:31]
    v_mfma_f32_16x16x32_bf16 v[32:35], a[40:43], a[56:59], v[32:35]
    v_mfma_f32_16x16x32_bf16 v[36:39], a[40:43], a[60:63], v[36:39]
    v_mfma_f32_16x16x32_bf16 v[40:43], a[40:43], a[64:67], v[40:43]
    v_mfma_f32_16x16x32_bf16 v[44:47], a[40:43], a[68:71], v[44:47]
    v_mfma_f32_16x16x32_bf16 v[48:51], a[44:47], a[56:59], v[48:51]
    v_mfma_f32_16x16x32_bf16 v[52:55], a[44:47], a[60:63], v[52:55]
    v_mfma_f32_16x16x32_bf16 v[56:59], a[44:47], a[64:67], v[56:59]
    v_mfma_f32_16x16x32_bf16 v[60:63], a[44:47], a[68:71], v[60:63]
    v_mfma_f32_16x16x32_bf16 v[64:67], a[48:51], a[56:59], v[64:67]
    v_mfma_f32_16x16x32_bf16 v[68:71], a[48:51], a[60:63], v[68:71]
    v_mfma_f32_16x16x32_bf16 v[72:75], a[48:51], a[64:67], v[72:75]
    v_mfma_f32_16x16x32_bf16 v[76:79], a[48:51], a[68:71], v[76:79]
    v_mfma_f32_16x16x32_bf16 v[80:83], a[52:55], a[56:59], v[80:83]
    v_mfma_f32_16x16x32_bf16 v[84:87], a[52:55], a[60:63], v[84:87]
    v_mfma_f32_16x16x32_bf16 v[88:91], a[52:55], a[64:67], v[88:91]
    v_mfma_f32_16x16x32_bf16 v[92:95], a[52:55], a[68:71], v[92:95]
    s_mul_i32 s42, s23, 20480
    v_add_u32 v15, s42, v1
    ds_write_b128 v15, v[16:19] offset:0
    ds_write_b128 v15, v[32:35] offset:1024
    ds_write_b128 v15, v[48:51] offset:2048
    ds_write_b128 v15, v[64:67] offset:3072
    ds_write_b128 v15, v[80:83] offset:4096
    s_waitcnt lgkmcnt(0)
    ds_write_b128 v15, v[20:23] offset:5120
    ds_write_b128 v15, v[36:39] offset:6144
    ds_write_b128 v15, v[52:55] offset:7168
    ds_write_b128 v15, v[68:71] offset:8192
    ds_write_b128 v15, v[84:87] offset:9216
    s_waitcnt lgkmcnt(0)
    ds_write_b128 v15, v[24:27] offset:10240
    ds_write_b128 v15, v[40:43] offset:11264
    ds_write_b128 v15, v[56:59] offset:12288
    ds_write_b128 v15, v[72:75] offset:13312
    ds_write_b128 v15, v[88:91] offset:14336
    s_waitcnt lgkmcnt(0)
    ds_write_b128 v15, v[28:31] offset:15360
    ds_write_b128 v15, v[44:47] offset:16384
    ds_write_b128 v15, v[60:63] offset:17408
    ds_write_b128 v15, v[76:79] offset:18432
    ds_write_b128 v15, v[92:95] offset:19456
    s_waitcnt lgkmcnt(0)
    s_barrier
    s_mul_i32 s42, s23, 5120
    v_add_u32 v15, s42, v1
    v_add_u32 v13, 40960, v15
    ds_read_b128 v[16:19], v15 offset:0
    ds_read_b128 v[20:23], v15 offset:1024
    ds_read_b128 v[24:27], v15 offset:2048
    ds_read_b128 v[28:31], v15 offset:3072
    ds_read_b128 v[32:35], v15 offset:4096
    ds_read_b128 v[36:39], v15 offset:20480
    ds_read_b128 v[40:43], v15 offset:21504
    ds_read_b128 v[44:47], v15 offset:22528
    ds_read_b128 v[48:51], v15 offset:23552
    ds_read_b128 v[52:55], v15 offset:24576
    s_waitcnt lgkmcnt(0)
    ds_read_b128 v[56:59], v13 offset:0
    ds_read_b128 v[60:63], v13 offset:1024
    ds_read_b128 v[64:67], v13 offset:2048
    ds_read_b128 v[68:71], v13 offset:3072
    ds_read_b128 v[72:75], v13 offset:4096
    ds_read_b128 v[76:79], v13 offset:20480
    ds_read_b128 v[80:83], v13 offset:21504
    ds_read_b128 v[84:87], v13 offset:22528
    ds_read_b128 v[88:91], v13 offset:23552
    ds_read_b128 v[92:95], v13 offset:24576
    s_waitcnt lgkmcnt(0)
    v_sub_f32 v101, 1.0, v100
    v_add_f32 v16, v16, v36
    v_add_f32 v56, v56, v76
    v_mul_f32 v16, v100, v16
    v_fmac_f32 v16, v101, v56
    v_add_f32 v17, v17, v37
    v_add_f32 v57, v57, v77
    v_mul_f32 v17, v100, v17
    v_fmac_f32 v17, v101, v57
    v_add_f32 v18, v18, v38
    v_add_f32 v58, v58, v78
    v_mul_f32 v18, v100, v18
    v_fmac_f32 v18, v101, v58
    v_add_f32 v19, v19, v39
    v_add_f32 v59, v59, v79
    v_mul_f32 v19, v100, v19
    v_fmac_f32 v19, v101, v59
    v_add_f32 v20, v20, v40
    v_add_f32 v60, v60, v80
    v_mul_f32 v20, v100, v20
    v_fmac_f32 v20, v101, v60
    v_add_f32 v21, v21, v41
    v_add_f32 v61, v61, v81
    v_mul_f32 v21, v100, v21
    v_fmac_f32 v21, v101, v61
    v_add_f32 v22, v22, v42
    v_add_f32 v62, v62, v82
    v_mul_f32 v22, v100, v22
    v_fmac_f32 v22, v101, v62
    v_add_f32 v23, v23, v43
    v_add_f32 v63, v63, v83
    v_mul_f32 v23, v100, v23
    v_fmac_f32 v23, v101, v63
    v_add_f32 v24, v24, v44
    v_add_f32 v64, v64, v84
    v_mul_f32 v24, v100, v24
    v_fmac_f32 v24, v101, v64
    v_add_f32 v25, v25, v45
    v_add_f32 v65, v65, v85
    v_mul_f32 v25, v100, v25
    v_fmac_f32 v25, v101, v65
    v_add_f32 v26, v26, v46
    v_add_f32 v66, v66, v86
    v_mul_f32 v26, v100, v26
    v_fmac_f32 v26, v101, v66
    v_add_f32 v27, v27, v47
    v_add_f32 v67, v67, v87
    v_mul_f32 v27, v100, v27
    v_fmac_f32 v27, v101, v67
    v_add_f32 v28, v28, v48
    v_add_f32 v68, v68, v88
    v_mul_f32 v28, v100, v28
    v_fmac_f32 v28, v101, v68
    v_add_f32 v29, v29, v49
    v_add_f32 v69, v69, v89
    v_mul_f32 v29, v100, v29
    v_fmac_f32 v29, v101, v69
    v_add_f32 v30, v30, v50
    v_add_f32 v70, v70, v90
    v_mul_f32 v30, v100, v30
    v_fmac_f32 v30, v101, v70
    v_add_f32 v31, v31, v51
    v_add_f32 v71, v71, v91
    v_mul_f32 v31, v100, v31
    v_fmac_f32 v31, v101, v71
    v_add_f32 v32, v32, v52
    v_add_f32 v72, v72, v92
    v_mul_f32 v32, v100, v32
    v_fmac_f32 v32, v101, v72
    v_add_f32 v33, v33, v53
    v_add_f32 v73, v73, v93
    v_mul_f32 v33, v100, v33
    v_fmac_f32 v33, v101, v73
    v_add_f32 v34, v34, v54
    v_add_f32 v74, v74, v94
    v_mul_f32 v34, v100, v34
    v_fmac_f32 v34, v101, v74
    v_add_f32 v35, v35, v55
    v_add_f32 v75, v75, v95
    v_mul_f32 v35, v100, v35
    v_fmac_f32 v35, v101, v75
    v_cvt_pk_bf16_f32 v36, v16, v17
    v_cvt_pk_bf16_f32 v37, v18, v19
    v_cvt_pk_bf16_f32 v38, v20, v21
    v_cvt_pk_bf16_f32 v39, v22, v23
    v_cvt_pk_bf16_f32 v40, v24, v25
    v_cvt_pk_bf16_f32 v41, v26, v27
    v_cvt_pk_bf16_f32 v42, v28, v29
    v_cvt_pk_bf16_f32 v43, v30, v31
    v_cvt_pk_bf16_f32 v44, v32, v33
    v_cvt_pk_bf16_f32 v45, v34, v35
    v_add_u32 v14, s46, v6
    v_mul_u32_u24 v14, 1280, v14
    v_mul_u32_u24 v15, 40, v7
    s_mul_i32 s42, s21, 160
    v_add3_u32 v14, v14, v15, s42
    buffer_store_dwordx4 v[36:39], v14, s[16:19], 0 offen
    buffer_store_dwordx4 v[40:43], v14, s[16:19], 0 offen offset:16
    buffer_store_dwordx2 v[44:45], v14, s[16:19], 0 offen offset:32
K3_END:
    s_endpgm
.section .rodata,"a"
.p2align 6
.amdhsa_kernel k1_kernel
  .amdhsa_next_free_vgpr 256
  .amdhsa_next_free_sgpr 102
  .amdhsa_accum_offset 256
  .amdhsa_group_segment_fixed_size 0
  .amdhsa_kernarg_size 88
  .amdhsa_user_sgpr_count 2
  .amdhsa_user_sgpr_kernarg_segment_ptr 1
  .amdhsa_system_sgpr_workgroup_id_x 1
.end_amdhsa_kernel
.p2align 6
.amdhsa_kernel k2_kernel
  .amdhsa_next_free_vgpr 128
  .amdhsa_next_free_sgpr 102
  .amdhsa_accum_offset 128
  .amdhsa_group_segment_fixed_size 0
  .amdhsa_kernarg_size 88
  .amdhsa_user_sgpr_count 2
  .amdhsa_user_sgpr_kernarg_segment_ptr 1
  .amdhsa_system_sgpr_workgroup_id_x 1
.end_amdhsa_kernel
.p2align 6
.amdhsa_kernel k3_kernel
  .amdhsa_next_free_vgpr 248
  .amdhsa_next_free_sgpr 102
  .amdhsa_accum_offset 104
  .amdhsa_group_segment_fixed_size 0
  .amdhsa_kernarg_size 88
  .amdhsa_user_sgpr_count 2
  .amdhsa_user_sgpr_kernarg_segment_ptr 1
  .amdhsa_system_sgpr_workgroup_id_x 1
.end_amdhsa_kernel
```
